```python
import torch

def _softmax(x, axis=-1):
    return torch.softmax(x, dim=axis)
def _gelu(x):
    return torch.nn.functional.gelu(x, approximate="tanh")
def _silu(x):
    return torch.nn.functional.silu(x)
def _sigmoid(x):
    return torch.sigmoid(x)
def _layernorm(x, axis=-1, eps=1e-5):
    m = x.mean(dim=axis, keepdim=True)
    v = x.var(dim=axis, keepdim=True, unbiased=False)
    return (x - m) / torch.sqrt(v + eps)
def _scatter_add(tgt, idx, src, axis=0):
    return tgt.clone().index_add_(axis, idx, src)
def _segment_sum(src, seg, n):
    out = torch.zeros((n,) + src.shape[1:], dtype=src.dtype)
    return out.index_add_(0, seg, src)
def _pad(x, pw):
    flat = tuple(v for pair in reversed(pw) for v in pair)
    return torch.nn.functional.pad(x, flat)

kernel_name = 'gated_mix__softmax_full_mha__swiglu_ffn__prompt'

def setup_inputs():

    _w = (lambda a: (lambda t: t.to(torch.bfloat16) if t.is_floating_point() else t)(torch.as_tensor(a)))
    def _A_setup():
        B, S, D = 1, 2048, 448
        return {
            "x": _w((lambda *s: torch.randn(*s, dtype=torch.bfloat16) * 0.05)(B, S, D)),
            "wqkv": _w((lambda *s: torch.randn(*s, dtype=torch.bfloat16) * 0.8)(D, 3 * D)),
            "wo": _w((lambda *s: torch.randn(*s, dtype=torch.bfloat16) * 0.05)(D, D)),
        }
    _A_in = _A_setup()

    def _B_setup():
        B, S, D, F = 1, 2048, 448, 1792
        return {
            "x": _w((lambda *s: torch.randn(*s, dtype=torch.bfloat16) * 0.05)(B, S, D)),
            "w_gate": _w((lambda *s: torch.randn(*s, dtype=torch.bfloat16) * 0.1)(D, F)),
            "w_up": _w((lambda *s: torch.randn(*s, dtype=torch.bfloat16) * 0.1)(D, F)),
            "w_down": _w((lambda *s: torch.randn(*s, dtype=torch.bfloat16) * 0.1)(F, D)),
        }
    _B_in = _B_setup()

    return {
        "A_x": _A_in["x"],
        "A_wqkv": _A_in["wqkv"],
        "A_wo": _A_in["wo"],
        "B_x": _B_in["x"],
        "B_w_gate": _B_in["w_gate"],
        "B_w_up": _B_in["w_up"],
        "B_w_down": _B_in["w_down"],
        "gate_w": _w((lambda *s: torch.randn(*s, dtype=torch.bfloat16) * 0.05)(448) * 16.0),
    }

def reference(A_x, A_wqkv, A_wo, B_x, B_w_gate, B_w_up, B_w_down, gate_w):
    def _A_ref(x, wqkv, wo):
        B, S, D = x.shape
        H = 16; Dh = D // H
        qkv = (lambda x, *d: x.permute(*d))((x @ wqkv).reshape(B, S, 3, H, Dh), 2, 0, 3, 1, 4)
        q, k, v = qkv[0], qkv[1], qkv[2]
        scale = Dh ** -0.5
        scores = torch.einsum("bhqd,bhkd->bhqk", q, k) * scale
        p = _softmax(scores, axis=-1)
        o = torch.einsum("bhqk,bhkd->bhqd", p, v)
        return (lambda x, *d: x.permute(*d))(o, 0, 2, 1, 3).reshape(B, S, D) @ wo

    def _B_ref(x, w_gate, w_up, w_down):
        g = _silu(x @ w_gate)
        u = x @ w_up
        return (g * u) @ w_down

    x = A_x
    g = _sigmoid((x * gate_w).sum(-1, keepdims=True))
    a = _A_ref(x, A_wqkv, A_wo)
    b = _B_ref(x, B_w_gate, B_w_up, B_w_down)
    return g * a + (1 - g) * b
```

```asm
; @launch grid=(256,1,1) block=(512,1,1) lds=163840
.amdgcn_target "amdgcn-amd-amdhsa--gfx950"
.text
.globl gated_mix__softmax_full_mha__swiglu_ffn__prompt_kernel
.p2align 8
.type gated_mix__softmax_full_mha__swiglu_ffn__prompt_kernel,@function
gated_mix__softmax_full_mha__swiglu_ffn__prompt_kernel:
    s_cmp_ge_u32 s2, 256
    s_cbranch_scc1 L_k12_end
    s_load_dwordx4 s[72:75], s[0:1], 0
    s_load_dwordx2 s[76:77], s[0:1], 16
    s_load_dwordx8 s[80:87], s[0:1], 32
    s_load_dwordx4 s[88:91], s[0:1], 72
    s_load_dwordx2 s[92:93], s[0:1], 64
    s_getpc_b64 s[52:53]
L_k12_pc:
    s_lshl_b32 s32, s2, 11
    s_and_b32 s32, s32, 0xc000
    v_lshlrev_b32 v250, 5, v0
    v_add_u32 v250, s32, v250
    v_min_u32 v250, L_code_end-L_k12_pc-4, v250
    v_mov_b32 v252, s53
    v_add_co_u32 v250, vcc, s52, v250
    s_nop 1
    v_addc_co_u32 v251, vcc, 0, v252, vcc
    global_load_dword v246, v[250:251], off
    s_and_b32 s68, s2, 7
    s_lshr_b32 s69, s2, 3
    s_and_b32 s25, s68, 1
    s_lshl_b32 s25, s25, 3
    s_and_b32 s3, s69, 7
    s_add_u32 s25, s25, s3
    s_lshr_b32 s32, s68, 1
    s_lshr_b32 s33, s69, 3
    s_mul_i32 s26, s32, 3
    s_add_u32 s26, s26, s33
    s_add_u32 s32, s32, 12
    s_cmp_eq_u32 s33, 3
    s_cselect_b32 s26, s32, s26
    s_lshl_b32 s33, s33, 1
    s_add_u32 s3, s3, s33
    s_sub_u32 s32, s3, 7
    s_cmp_ge_u32 s3, 7
    s_cselect_b32 s3, s32, s3
    v_lshrrev_b32 v250, 6, v0
    v_and_b32 v253, 63, v0
    v_readfirstlane_b32 s24, v250
    v_lshlrev_b32 v254, 4, v253
    s_and_b32 s28, s24, 3
    s_cmp_lt_u32 s24, 4
    s_cbranch_scc1 L_k12_heavy
    s_setprio 3
    s_cmp_ge_u32 s26, 12
    s_cbranch_scc1 L_k12_loadY
    v_lshrrev_b32 v250, 3, v253
    v_and_b32 v251, 7, v253
    v_lshrrev_b32 v252, 1, v250
    v_xor_b32 v252, v252, v251
    v_mul_u32_u24 v1, 896, v250
    v_lshl_add_u32 v1, v252, 4, v1
    v_xor_b32 v2, 64, v1
    v_add_u32 v3, 12288, v1
    v_add_u32 v4, 18432, v2
    v_add_u32 v2, 6144, v2
    v_bfe_u32 v251, v253, 2, 1
    v_bfe_u32 v252, v253, 4, 1
    v_xor_b32 v251, v251, v252
    v_and_b32 v252, 3, v253
    v_mul_u32_u24 v5, 3584, v250
    v_mul_u32_u24 v6, 64, v251
    v_add_u32 v5, v5, v6
    v_lshl_add_u32 v5, v252, 4, v5
    v_add_u32 v6, 27648, v5
    v_mul_u32_u24 v7, 2688, v250
    v_mul_u32_u24 v8, 56, v251
    v_add_u32 v7, v7, v8
    v_lshl_add_u32 v7, v252, 4, v7
    v_add_u32 v8, 20480, v7
    s_lshl_b32 s32, s25, 2
    s_add_u32 s32, s32, s28
    s_mul_i32 s29, s32, 28672
    s_mul_i32 s32, s28, 57344
    s_lshl_b32 s30, s26, 7
    s_add_u32 s30, s30, s32
    s_mul_i32 s32, s28, 43008
    s_mul_i32 s34, s26, 112
    s_add_u32 s34, s34, s32
    s_lshl_b32 s35, s28, 12
    s_lshl_b32 s36, s28, 11
    s_add_u32 s36, s36, 114688
    s_mov_b32 s37, s3
    s_add_u32 s38, s37, 1
    s_cmp_eq_u32 s38, 7
    s_cselect_b32 s38, 0, s38
    s_add_u32 s39, s38, 1
    s_cmp_eq_u32 s39, 7
    s_cselect_b32 s39, 0, s39
    s_add_u32 s40, s39, 1
    s_cmp_eq_u32 s40, 7
    s_cselect_b32 s40, 0, s40
    s_add_u32 s41, s40, 1
    s_cmp_eq_u32 s41, 7
    s_cselect_b32 s41, 0, s41
    s_add_u32 s42, s41, 1
    s_cmp_eq_u32 s42, 7
    s_cselect_b32 s42, 0, s42
    s_add_u32 s43, s42, 1
    s_cmp_eq_u32 s43, 7
    s_cselect_b32 s43, 0, s43
    s_waitcnt lgkmcnt(0)
    s_mov_b32 s4, s72
    s_mov_b32 s5, s73
    s_mov_b32 s6, 1835008
    s_mov_b32 s7, 0x20000
    s_mov_b32 s8, s80
    s_mov_b32 s9, s81
    s_mov_b32 s10, 1605632
    s_mov_b32 s11, 0x20000
    s_mov_b32 s12, s82
    s_mov_b32 s13, s83
    s_mov_b32 s14, 1605632
    s_mov_b32 s15, 0x20000
    s_mov_b32 s16, s74
    s_mov_b32 s17, s75
    s_mov_b32 s18, 1204224
    s_mov_b32 s19, 0x20000
    s_lshl_b32 s32, s37, 7
    s_add_u32 m0, s35, 0
    s_add_u32 s32, s32, s29
    buffer_load_dwordx4 v1, s[4:7], s32 offen offset:0 lds
    buffer_load_dwordx4 v2, s[4:7], s32 offen offset:1024 lds
    buffer_load_dwordx4 v3, s[4:7], s32 offen offset:2048 lds
    buffer_load_dwordx4 v4, s[4:7], s32 offen offset:3072 lds
    s_mul_i32 s33, s37, 172032
    s_add_u32 m0, s36, 0
    s_add_u32 s32, s34, s33
    buffer_load_dwordx4 v7, s[16:19], s32 offen offset:0 lds
    buffer_load_dwordx4 v8, s[16:19], s32 offen offset:1024 lds
    s_lshl_b32 s32, s38, 7
    s_add_u32 m0, s35, 16384
    s_add_u32 s32, s32, s29
    buffer_load_dwordx4 v1, s[4:7], s32 offen offset:0 lds
    buffer_load_dwordx4 v2, s[4:7], s32 offen offset:1024 lds
    buffer_load_dwordx4 v3, s[4:7], s32 offen offset:2048 lds
    buffer_load_dwordx4 v4, s[4:7], s32 offen offset:3072 lds
    s_mul_i32 s33, s38, 172032
    s_add_u32 m0, s36, 8192
    s_add_u32 s32, s34, s33
    buffer_load_dwordx4 v7, s[16:19], s32 offen offset:0 lds
    buffer_load_dwordx4 v8, s[16:19], s32 offen offset:1024 lds
    s_mov_b32 s60, s86
    s_mov_b32 s61, s87
    s_mov_b32 s62, 896
    s_mov_b32 s63, 0x20000
    v_and_b32 v250, 15, v253
    v_lshlrev_b32 v251, 1, v250
    s_lshl_b32 s32, s28, 5
    s_lshl_b32 s31, s26, 12
    s_add_u32 s32, s32, s31
    s_lshl_b32 s31, s37, 7
    s_add_u32 s31, s31, s32
    buffer_load_ushort v16, v251, s[60:63], s31 offen
    s_lshl_b32 s31, s38, 7
    s_add_u32 s31, s31, s32
    buffer_load_ushort v17, v251, s[60:63], s31 offen
    s_lshl_b32 s31, s39, 7
    s_add_u32 s31, s31, s32
    buffer_load_ushort v18, v251, s[60:63], s31 offen
    s_lshl_b32 s31, s40, 7
    s_add_u32 s31, s31, s32
    buffer_load_ushort v19, v251, s[60:63], s31 offen
    s_lshl_b32 s31, s41, 7
    s_add_u32 s31, s31, s32
    buffer_load_ushort v20, v251, s[60:63], s31 offen
    s_lshl_b32 s31, s42, 7
    s_add_u32 s31, s31, s32
    buffer_load_ushort v21, v251, s[60:63], s31 offen
    s_lshl_b32 s31, s43, 7
    s_add_u32 s31, s31, s32
    buffer_load_ushort v22, v251, s[60:63], s31 offen
    v_lshlrev_b32 v13, 7, v250
    v_bfe_u32 v251, v253, 1, 1
    v_lshl_add_u32 v13, v251, 6, v13
    v_add_u32 v13, s36, v13
    v_add_u32 v13, 56, v13
    s_lshl_b32 s32, s39, 7
    s_add_u32 m0, s35, 32768
    s_add_u32 s32, s32, s29
    buffer_load_dwordx4 v1, s[4:7], s32 offen offset:0 lds
    buffer_load_dwordx4 v2, s[4:7], s32 offen offset:1024 lds
    buffer_load_dwordx4 v3, s[4:7], s32 offen offset:2048 lds
    buffer_load_dwordx4 v4, s[4:7], s32 offen offset:3072 lds
    s_mul_i32 s33, s39, 172032
    s_add_u32 m0, s36, 16384
    s_add_u32 s32, s34, s33
    buffer_load_dwordx4 v7, s[16:19], s32 offen offset:0 lds
    buffer_load_dwordx4 v8, s[16:19], s32 offen offset:1024 lds
    s_lshl_b32 s32, s40, 7
    s_add_u32 m0, s35, 49152
    s_add_u32 s32, s32, s29
    buffer_load_dwordx4 v1, s[4:7], s32 offen offset:0 lds
    buffer_load_dwordx4 v2, s[4:7], s32 offen offset:1024 lds
    buffer_load_dwordx4 v3, s[4:7], s32 offen offset:2048 lds
    buffer_load_dwordx4 v4, s[4:7], s32 offen offset:3072 lds
    s_mul_i32 s33, s40, 172032
    s_add_u32 m0, s36, 24576
    s_add_u32 s32, s34, s33
    buffer_load_dwordx4 v7, s[16:19], s32 offen offset:0 lds
    buffer_load_dwordx4 v8, s[16:19], s32 offen offset:1024 lds
    s_mov_b32 s20, s90
    s_mov_b32 s21, s91
    s_mov_b32 s22, 19922944
    s_mov_b32 s23, 0x20000
    v_mov_b32 v12, 0
    s_mov_b32 s32, 19136512
    buffer_load_dword v11, v12, s[20:23], s32 offen offset:0 sc1
    s_waitcnt vmcnt(20)
    s_mov_b64 exec, 0xffff
    s_waitcnt vmcnt(19)
    ds_write_b16 v13, v16 offset:0
    s_waitcnt vmcnt(18)
    ds_write_b16 v13, v17 offset:8192
    s_mov_b64 exec, -1
    s_waitcnt lgkmcnt(0)
    s_barrier
    s_lshl_b32 s32, s41, 7
    s_add_u32 m0, s35, 65536
    s_add_u32 s32, s32, s29
    buffer_load_dwordx4 v1, s[4:7], s32 offen offset:0 lds
    buffer_load_dwordx4 v2, s[4:7], s32 offen offset:1024 lds
    buffer_load_dwordx4 v3, s[4:7], s32 offen offset:2048 lds
    buffer_load_dwordx4 v4, s[4:7], s32 offen offset:3072 lds
    s_mul_i32 s33, s41, 172032
    s_add_u32 m0, s36, 32768
    s_add_u32 s32, s34, s33
    buffer_load_dwordx4 v7, s[16:19], s32 offen offset:0 lds
    buffer_load_dwordx4 v8, s[16:19], s32 offen offset:1024 lds
    s_lshl_b32 s32, s42, 7
    s_add_u32 m0, s35, 81920
    s_add_u32 s32, s32, s29
    buffer_load_dwordx4 v1, s[4:7], s32 offen offset:0 lds
    buffer_load_dwordx4 v2, s[4:7], s32 offen offset:1024 lds
    buffer_load_dwordx4 v3, s[4:7], s32 offen offset:2048 lds
    buffer_load_dwordx4 v4, s[4:7], s32 offen offset:3072 lds
    s_mul_i32 s33, s42, 172032
    s_add_u32 m0, s36, 40960
    s_add_u32 s32, s34, s33
    buffer_load_dwordx4 v7, s[16:19], s32 offen offset:0 lds
    buffer_load_dwordx4 v8, s[16:19], s32 offen offset:1024 lds
    s_waitcnt vmcnt(13)
    s_mov_b64 exec, 0xffff
    ds_write_b16 v13, v18 offset:16384
    ds_write_b16 v13, v19 offset:24576
    s_mov_b64 exec, -1
    s_waitcnt lgkmcnt(0)
    s_barrier
    s_lshl_b32 s32, s43, 7
    s_add_u32 m0, s35, 98304
    s_add_u32 s32, s32, s29
    buffer_load_dwordx4 v1, s[4:7], s32 offen offset:0 lds
    buffer_load_dwordx4 v2, s[4:7], s32 offen offset:1024 lds
    buffer_load_dwordx4 v3, s[4:7], s32 offen offset:2048 lds
    buffer_load_dwordx4 v4, s[4:7], s32 offen offset:3072 lds
    s_mul_i32 s33, s43, 172032
    s_add_u32 m0, s36, 0
    s_add_u32 s32, s34, s33
    buffer_load_dwordx4 v7, s[16:19], s32 offen offset:0 lds
    buffer_load_dwordx4 v8, s[16:19], s32 offen offset:1024 lds
    s_waitcnt vmcnt(6)
    s_mov_b64 exec, 0xffff
    ds_write_b16 v13, v20 offset:32768
    ds_write_b16 v13, v21 offset:40960
    s_mov_b64 exec, -1
    s_waitcnt lgkmcnt(0)
    s_barrier
    s_mul_i32 s33, s37, 229376
    s_add_u32 s33, s33, s30
    s_add_u32 m0, s36, 16384
    s_nop 0
    buffer_load_dwordx4 v5, s[8:11], s33 offen offset:0 lds
    buffer_load_dwordx4 v6, s[8:11], s33 offen offset:1024 lds
    s_add_u32 m0, s36, 24576
    s_nop 0
    buffer_load_dwordx4 v5, s[12:15], s33 offen offset:0 lds
    buffer_load_dwordx4 v6, s[12:15], s33 offen offset:1024 lds
    v_readfirstlane_b32 s27, v11
    s_nop 0
    s_add_u32 s27, s27, 0x9e3779b9
    s_waitcnt vmcnt(4)
    s_mov_b64 exec, 0xffff
    ds_write_b16 v13, v22 offset:0
    s_mov_b64 exec, -1
    s_waitcnt lgkmcnt(0)
    s_barrier
    s_mul_i32 s33, s38, 229376
    s_add_u32 s33, s33, s30
    s_add_u32 m0, s36, 32768
    s_nop 0
    buffer_load_dwordx4 v5, s[8:11], s33 offen offset:0 lds
    buffer_load_dwordx4 v6, s[8:11], s33 offen offset:1024 lds
    s_add_u32 m0, s36, 40960
    s_nop 0
    buffer_load_dwordx4 v5, s[12:15], s33 offen offset:0 lds
    buffer_load_dwordx4 v6, s[12:15], s33 offen offset:1024 lds
    s_waitcnt vmcnt(4)
    s_barrier
    s_mul_i32 s33, s39, 229376
    s_add_u32 s33, s33, s30
    s_add_u32 m0, s36, 0
    s_nop 0
    buffer_load_dwordx4 v5, s[8:11], s33 offen offset:0 lds
    buffer_load_dwordx4 v6, s[8:11], s33 offen offset:1024 lds
    s_add_u32 m0, s36, 8192
    s_nop 0
    buffer_load_dwordx4 v5, s[12:15], s33 offen offset:0 lds
    buffer_load_dwordx4 v6, s[12:15], s33 offen offset:1024 lds
    s_waitcnt vmcnt(4)
    s_barrier
    s_mul_i32 s33, s40, 229376
    s_add_u32 s33, s33, s30
    s_add_u32 m0, s36, 16384
    s_nop 0
    buffer_load_dwordx4 v5, s[8:11], s33 offen offset:0 lds
    buffer_load_dwordx4 v6, s[8:11], s33 offen offset:1024 lds
    s_add_u32 m0, s36, 24576
    s_nop 0
    buffer_load_dwordx4 v5, s[12:15], s33 offen offset:0 lds
    buffer_load_dwordx4 v6, s[12:15], s33 offen offset:1024 lds
    s_waitcnt vmcnt(4)
    s_barrier
    s_mul_i32 s33, s41, 229376
    s_add_u32 s33, s33, s30
    s_add_u32 m0, s36, 32768
    s_nop 0
    buffer_load_dwordx4 v5, s[8:11], s33 offen offset:0 lds
    buffer_load_dwordx4 v6, s[8:11], s33 offen offset:1024 lds
    s_add_u32 m0, s36, 40960
    s_nop 0
    buffer_load_dwordx4 v5, s[12:15], s33 offen offset:0 lds
    buffer_load_dwordx4 v6, s[12:15], s33 offen offset:1024 lds
    s_waitcnt vmcnt(4)
    s_barrier
    s_mul_i32 s33, s42, 229376
    s_add_u32 s33, s33, s30
    s_add_u32 m0, s36, 0
    s_nop 0
    buffer_load_dwordx4 v5, s[8:11], s33 offen offset:0 lds
    buffer_load_dwordx4 v6, s[8:11], s33 offen offset:1024 lds
    s_add_u32 m0, s36, 8192
    s_nop 0
    buffer_load_dwordx4 v5, s[12:15], s33 offen offset:0 lds
    buffer_load_dwordx4 v6, s[12:15], s33 offen offset:1024 lds
    s_waitcnt vmcnt(4)
    s_barrier
    s_mul_i32 s33, s43, 229376
    s_add_u32 s33, s33, s30
    s_add_u32 m0, s36, 16384
    s_nop 0
    buffer_load_dwordx4 v5, s[8:11], s33 offen offset:0 lds
    buffer_load_dwordx4 v6, s[8:11], s33 offen offset:1024 lds
    s_add_u32 m0, s36, 24576
    s_nop 0
    buffer_load_dwordx4 v5, s[12:15], s33 offen offset:0 lds
    buffer_load_dwordx4 v6, s[12:15], s33 offen offset:1024 lds
    s_waitcnt vmcnt(4)
    s_barrier
    s_mul_i32 s33, s37, 229376
    s_add_u32 s33, s33, s30
    s_add_u32 s33, s33, 1536
    s_add_u32 m0, s36, 32768
    s_nop 0
    buffer_load_dwordx4 v5, s[8:11], s33 offen offset:0 lds
    buffer_load_dwordx4 v6, s[8:11], s33 offen offset:1024 lds
    s_add_u32 m0, s36, 40960
    s_nop 0
    buffer_load_dwordx4 v5, s[12:15], s33 offen offset:0 lds
    buffer_load_dwordx4 v6, s[12:15], s33 offen offset:1024 lds
    s_lshl_b32 s32, s26, 4
    s_add_u32 s32, s32, s25
    s_lshl_b32 s32, s32, 7
    s_add_u32 s32, s32, 18939904
    s_min_u32 s33, s28, 1
    s_lshl_b32 s33, s33, 19
    s_add_u32 s32, s32, s33
    v_mov_b32 v9, s27
    v_mov_b32 v249, 0
    s_mov_b64 exec, 1
    buffer_store_dword v9, v249, s[20:23], s32 offen offset:0 sc1
    s_mov_b64 exec, -1
    s_waitcnt vmcnt(5)
    s_barrier
    s_mul_i32 s33, s38, 229376
    s_add_u32 s33, s33, s30
    s_add_u32 s33, s33, 1536
    s_add_u32 m0, s36, 0
    s_nop 0
    buffer_load_dwordx4 v5, s[8:11], s33 offen offset:0 lds
    buffer_load_dwordx4 v6, s[8:11], s33 offen offset:1024 lds
    s_add_u32 m0, s36, 8192
    s_nop 0
    buffer_load_dwordx4 v5, s[12:15], s33 offen offset:0 lds
    buffer_load_dwordx4 v6, s[12:15], s33 offen offset:1024 lds
    s_waitcnt vmcnt(5)
    s_barrier
    s_mul_i32 s33, s39, 229376
    s_add_u32 s33, s33, s30
    s_add_u32 s33, s33, 1536
    s_add_u32 m0, s36, 16384
    s_nop 0
    buffer_load_dwordx4 v5, s[8:11], s33 offen offset:0 lds
    buffer_load_dwordx4 v6, s[8:11], s33 offen offset:1024 lds
    s_add_u32 m0, s36, 24576
    s_nop 0
    buffer_load_dwordx4 v5, s[12:15], s33 offen offset:0 lds
    buffer_load_dwordx4 v6, s[12:15], s33 offen offset:1024 lds
    s_waitcnt vmcnt(4)
    s_barrier
    s_mul_i32 s33, s40, 229376
    s_add_u32 s33, s33, s30
    s_add_u32 s33, s33, 1536
    s_add_u32 m0, s36, 32768
    s_nop 0
    buffer_load_dwordx4 v5, s[8:11], s33 offen offset:0 lds
    buffer_load_dwordx4 v6, s[8:11], s33 offen offset:1024 lds
    s_add_u32 m0, s36, 40960
    s_nop 0
    buffer_load_dwordx4 v5, s[12:15], s33 offen offset:0 lds
    buffer_load_dwordx4 v6, s[12:15], s33 offen offset:1024 lds
    s_waitcnt vmcnt(4)
    s_barrier
    s_mul_i32 s33, s41, 229376
    s_add_u32 s33, s33, s30
    s_add_u32 s33, s33, 1536
    s_add_u32 m0, s36, 0
    s_nop 0
    buffer_load_dwordx4 v5, s[8:11], s33 offen offset:0 lds
    buffer_load_dwordx4 v6, s[8:11], s33 offen offset:1024 lds
    s_add_u32 m0, s36, 8192
    s_nop 0
    buffer_load_dwordx4 v5, s[12:15], s33 offen offset:0 lds
    buffer_load_dwordx4 v6, s[12:15], s33 offen offset:1024 lds
    s_waitcnt vmcnt(4)
    s_barrier
    s_mul_i32 s33, s42, 229376
    s_add_u32 s33, s33, s30
    s_add_u32 s33, s33, 1536
    s_add_u32 m0, s36, 16384
    s_nop 0
    buffer_load_dwordx4 v5, s[8:11], s33 offen offset:0 lds
    buffer_load_dwordx4 v6, s[8:11], s33 offen offset:1024 lds
    s_add_u32 m0, s36, 24576
    s_nop 0
    buffer_load_dwordx4 v5, s[12:15], s33 offen offset:0 lds
    buffer_load_dwordx4 v6, s[12:15], s33 offen offset:1024 lds
    s_waitcnt vmcnt(4)
    s_barrier
    s_mul_i32 s33, s43, 229376
    s_add_u32 s33, s33, s30
    s_add_u32 s33, s33, 1536
    s_add_u32 m0, s36, 32768
    s_nop 0
    buffer_load_dwordx4 v5, s[8:11], s33 offen offset:0 lds
    buffer_load_dwordx4 v6, s[8:11], s33 offen offset:1024 lds
    s_add_u32 m0, s36, 40960
    s_nop 0
    buffer_load_dwordx4 v5, s[12:15], s33 offen offset:0 lds
    buffer_load_dwordx4 v6, s[12:15], s33 offen offset:1024 lds
    s_lshl_b32 s32, s68, 4
    s_add_u32 s33, s32, 128
    v_add_u32 v14, s33, v253
    s_lshr_b32 s33, s68, 1
    s_lshl_b32 s33, s33, 4
    s_add_u32 s33, s33, 176
    v_add_u32 v250, s33, v253
    v_cmp_le_u32 vcc, 16, v253
    s_nop 1
    v_cndmask_b32 v14, v14, v250, vcc
    s_and_b32 s33, s69, 15
    s_add_u32 s32, s32, s33
    v_mov_b32 v250, s32
    v_cmp_le_u32 vcc, 32, v253
    s_nop 1
    v_cndmask_b32 v14, v14, v250, vcc
    v_lshlrev_b32 v14, 7, v14
    s_waitcnt vmcnt(4)
    s_barrier
    s_branch L_k12_help2
L_k12_loadY:
    v_lshrrev_b32 v250, 3, v253
    v_and_b32 v251, 7, v253
    v_lshrrev_b32 v252, 1, v250
    v_xor_b32 v252, v252, v251
    v_mul_u32_u24 v1, 896, v250
    v_lshl_add_u32 v1, v252, 4, v1
    v_xor_b32 v2, 64, v1
    v_add_u32 v3, 12288, v1
    v_add_u32 v4, 18432, v2
    v_add_u32 v2, 6144, v2
    v_bfe_u32 v251, v253, 2, 1
    v_bfe_u32 v252, v253, 4, 1
    v_xor_b32 v251, v251, v252
    v_and_b32 v252, 3, v253
    v_mul_u32_u24 v5, 3584, v250
    v_mul_u32_u24 v6, 64, v251
    v_add_u32 v5, v5, v6
    v_lshl_add_u32 v5, v252, 4, v5
    v_add_u32 v6, 27648, v5
    v_mul_u32_u24 v7, 2688, v250
    v_mul_u32_u24 v8, 56, v251
    v_add_u32 v7, v7, v8
    v_lshl_add_u32 v7, v252, 4, v7
    v_add_u32 v8, 20480, v7
    s_lshl_b32 s32, s25, 2
    s_add_u32 s32, s32, s28
    s_mul_i32 s29, s32, 28672
    s_mul_i32 s32, s28, 57344
    s_lshl_b32 s30, s26, 7
    s_add_u32 s30, s30, s32
    s_mul_i32 s32, s28, 43008
    s_mul_i32 s34, s26, 112
    s_add_u32 s34, s34, s32
    s_mul_i32 s48, s26, 224
    s_add_u32 s48, s48, s32
    s_sub_u32 s48, s48, 896
    s_lshl_b32 s35, s28, 12
    s_lshl_b32 s36, s28, 11
    s_add_u32 s36, s36, 114688
    s_mov_b32 s37, s3
    s_add_u32 s38, s37, 1
    s_cmp_eq_u32 s38, 7
    s_cselect_b32 s38, 0, s38
    s_add_u32 s39, s38, 1
    s_cmp_eq_u32 s39, 7
    s_cselect_b32 s39, 0, s39
    s_add_u32 s40, s39, 1
    s_cmp_eq_u32 s40, 7
    s_cselect_b32 s40, 0, s40
    s_add_u32 s41, s40, 1
    s_cmp_eq_u32 s41, 7
    s_cselect_b32 s41, 0, s41
    s_add_u32 s42, s41, 1
    s_cmp_eq_u32 s42, 7
    s_cselect_b32 s42, 0, s42
    s_add_u32 s43, s42, 1
    s_cmp_eq_u32 s43, 7
    s_cselect_b32 s43, 0, s43
    s_waitcnt lgkmcnt(0)
    s_mov_b32 s4, s72
    s_mov_b32 s5, s73
    s_mov_b32 s6, 1835008
    s_mov_b32 s7, 0x20000
    s_mov_b32 s8, s80
    s_mov_b32 s9, s81
    s_mov_b32 s10, 1605632
    s_mov_b32 s11, 0x20000
    s_mov_b32 s12, s82
    s_mov_b32 s13, s83
    s_mov_b32 s14, 1605632
    s_mov_b32 s15, 0x20000
    s_mov_b32 s16, s74
    s_mov_b32 s17, s75
    s_mov_b32 s18, 1204224
    s_mov_b32 s19, 0x20000
    s_lshl_b32 s32, s37, 7
    s_add_u32 m0, s35, 0
    s_add_u32 s32, s32, s29
    buffer_load_dwordx4 v1, s[4:7], s32 offen offset:0 lds
    buffer_load_dwordx4 v2, s[4:7], s32 offen offset:1024 lds
    buffer_load_dwordx4 v3, s[4:7], s32 offen offset:2048 lds
    buffer_load_dwordx4 v4, s[4:7], s32 offen offset:3072 lds
    s_mul_i32 s33, s37, 172032
    s_add_u32 m0, s36, 0
    s_add_u32 s33, s33, s48
    buffer_load_dwordx4 v7, s[16:19], s33 offen offset:0 lds
    buffer_load_dwordx4 v8, s[16:19], s33 offen offset:1024 lds
    s_add_u32 m0, s36, 8192
    s_add_u32 s33, s33, 112
    buffer_load_dwordx4 v7, s[16:19], s33 offen offset:0 lds
    buffer_load_dwordx4 v8, s[16:19], s33 offen offset:1024 lds
    s_lshl_b32 s32, s38, 7
    s_add_u32 m0, s35, 16384
    s_add_u32 s32, s32, s29
    buffer_load_dwordx4 v1, s[4:7], s32 offen offset:0 lds
    buffer_load_dwordx4 v2, s[4:7], s32 offen offset:1024 lds
    buffer_load_dwordx4 v3, s[4:7], s32 offen offset:2048 lds
    buffer_load_dwordx4 v4, s[4:7], s32 offen offset:3072 lds
    s_mul_i32 s33, s38, 172032
    s_add_u32 m0, s36, 16384
    s_add_u32 s33, s33, s48
    buffer_load_dwordx4 v7, s[16:19], s33 offen offset:0 lds
    buffer_load_dwordx4 v8, s[16:19], s33 offen offset:1024 lds
    s_add_u32 m0, s36, 24576
    s_add_u32 s33, s33, 112
    buffer_load_dwordx4 v7, s[16:19], s33 offen offset:0 lds
    buffer_load_dwordx4 v8, s[16:19], s33 offen offset:1024 lds
    s_mov_b32 s20, s90
    s_mov_b32 s21, s91
    s_mov_b32 s22, 19922944
    s_mov_b32 s23, 0x20000
    v_mov_b32 v12, 0
    s_mov_b32 s32, 19136512
    buffer_load_dword v11, v12, s[20:23], s32 offen offset:0 sc1
    s_waitcnt vmcnt(9)
    s_barrier
    s_lshl_b32 s32, s39, 7
    s_add_u32 m0, s35, 32768
    s_add_u32 s32, s32, s29
    buffer_load_dwordx4 v1, s[4:7], s32 offen offset:0 lds
    buffer_load_dwordx4 v2, s[4:7], s32 offen offset:1024 lds
    buffer_load_dwordx4 v3, s[4:7], s32 offen offset:2048 lds
    buffer_load_dwordx4 v4, s[4:7], s32 offen offset:3072 lds
    s_mul_i32 s33, s39, 172032
    s_add_u32 m0, s36, 32768
    s_add_u32 s33, s33, s48
    buffer_load_dwordx4 v7, s[16:19], s33 offen offset:0 lds
    buffer_load_dwordx4 v8, s[16:19], s33 offen offset:1024 lds
    s_add_u32 m0, s36, 40960
    s_add_u32 s33, s33, 112
    buffer_load_dwordx4 v7, s[16:19], s33 offen offset:0 lds
    buffer_load_dwordx4 v8, s[16:19], s33 offen offset:1024 lds
    s_waitcnt vmcnt(9)
    s_barrier
    s_lshl_b32 s32, s40, 7
    s_add_u32 m0, s35, 49152
    s_add_u32 s32, s32, s29
    buffer_load_dwordx4 v1, s[4:7], s32 offen offset:0 lds
    buffer_load_dwordx4 v2, s[4:7], s32 offen offset:1024 lds
    buffer_load_dwordx4 v3, s[4:7], s32 offen offset:2048 lds
    buffer_load_dwordx4 v4, s[4:7], s32 offen offset:3072 lds
    s_mul_i32 s33, s40, 172032
    s_add_u32 m0, s36, 0
    s_add_u32 s33, s33, s48
    buffer_load_dwordx4 v7, s[16:19], s33 offen offset:0 lds
    buffer_load_dwordx4 v8, s[16:19], s33 offen offset:1024 lds
    s_add_u32 m0, s36, 8192
    s_add_u32 s33, s33, 112
    buffer_load_dwordx4 v7, s[16:19], s33 offen offset:0 lds
    buffer_load_dwordx4 v8, s[16:19], s33 offen offset:1024 lds
    s_waitcnt vmcnt(8)
    s_barrier
    s_lshl_b32 s32, s41, 7
    s_add_u32 m0, s35, 65536
    s_add_u32 s32, s32, s29
    buffer_load_dwordx4 v1, s[4:7], s32 offen offset:0 lds
    buffer_load_dwordx4 v2, s[4:7], s32 offen offset:1024 lds
    buffer_load_dwordx4 v3, s[4:7], s32 offen offset:2048 lds
    buffer_load_dwordx4 v4, s[4:7], s32 offen offset:3072 lds
    s_mul_i32 s33, s41, 172032
    s_add_u32 m0, s36, 16384
    s_add_u32 s33, s33, s48
    buffer_load_dwordx4 v7, s[16:19], s33 offen offset:0 lds
    buffer_load_dwordx4 v8, s[16:19], s33 offen offset:1024 lds
    s_add_u32 m0, s36, 24576
    s_add_u32 s33, s33, 112
    buffer_load_dwordx4 v7, s[16:19], s33 offen offset:0 lds
    buffer_load_dwordx4 v8, s[16:19], s33 offen offset:1024 lds
    v_readfirstlane_b32 s27, v11
    s_nop 0
    s_add_u32 s27, s27, 0x9e3779b9
    s_waitcnt vmcnt(8)
    s_barrier
    s_lshl_b32 s32, s42, 7
    s_add_u32 m0, s35, 81920
    s_add_u32 s32, s32, s29
    buffer_load_dwordx4 v1, s[4:7], s32 offen offset:0 lds
    buffer_load_dwordx4 v2, s[4:7], s32 offen offset:1024 lds
    buffer_load_dwordx4 v3, s[4:7], s32 offen offset:2048 lds
    buffer_load_dwordx4 v4, s[4:7], s32 offen offset:3072 lds
    s_mul_i32 s33, s42, 172032
    s_add_u32 m0, s36, 32768
    s_add_u32 s33, s33, s48
    buffer_load_dwordx4 v7, s[16:19], s33 offen offset:0 lds
    buffer_load_dwordx4 v8, s[16:19], s33 offen offset:1024 lds
    s_add_u32 m0, s36, 40960
    s_add_u32 s33, s33, 112
    buffer_load_dwordx4 v7, s[16:19], s33 offen offset:0 lds
    buffer_load_dwordx4 v8, s[16:19], s33 offen offset:1024 lds
    s_waitcnt vmcnt(8)
    s_barrier
    s_lshl_b32 s32, s43, 7
    s_add_u32 m0, s35, 98304
    s_add_u32 s32, s32, s29
    buffer_load_dwordx4 v1, s[4:7], s32 offen offset:0 lds
    buffer_load_dwordx4 v2, s[4:7], s32 offen offset:1024 lds
    buffer_load_dwordx4 v3, s[4:7], s32 offen offset:2048 lds
    buffer_load_dwordx4 v4, s[4:7], s32 offen offset:3072 lds
    s_mul_i32 s33, s43, 172032
    s_add_u32 m0, s36, 0
    s_add_u32 s33, s33, s48
    buffer_load_dwordx4 v7, s[16:19], s33 offen offset:0 lds
    buffer_load_dwordx4 v8, s[16:19], s33 offen offset:1024 lds
    s_add_u32 m0, s36, 8192
    s_add_u32 s33, s33, 112
    buffer_load_dwordx4 v7, s[16:19], s33 offen offset:0 lds
    buffer_load_dwordx4 v8, s[16:19], s33 offen offset:1024 lds
    s_waitcnt vmcnt(8)
    s_barrier
    s_mul_i32 s33, s37, 172032
    s_add_u32 m0, s36, 16384
    s_add_u32 s32, s34, s33
    buffer_load_dwordx4 v7, s[16:19], s32 offen offset:0 lds
    buffer_load_dwordx4 v8, s[16:19], s32 offen offset:1024 lds
    s_mul_i32 s33, s38, 172032
    s_add_u32 m0, s36, 24576
    s_add_u32 s32, s34, s33
    buffer_load_dwordx4 v7, s[16:19], s32 offen offset:0 lds
    buffer_load_dwordx4 v8, s[16:19], s32 offen offset:1024 lds
    s_waitcnt vmcnt(4)
    s_barrier
    s_mul_i32 s33, s39, 172032
    s_add_u32 m0, s36, 32768
    s_add_u32 s32, s34, s33
    buffer_load_dwordx4 v7, s[16:19], s32 offen offset:0 lds
    buffer_load_dwordx4 v8, s[16:19], s32 offen offset:1024 lds
    s_mul_i32 s33, s40, 172032
    s_add_u32 m0, s36, 40960
    s_add_u32 s32, s34, s33
    buffer_load_dwordx4 v7, s[16:19], s32 offen offset:0 lds
    buffer_load_dwordx4 v8, s[16:19], s32 offen offset:1024 lds
    s_waitcnt vmcnt(4)
    s_barrier
    s_mul_i32 s33, s41, 172032
    s_add_u32 m0, s36, 0
    s_add_u32 s32, s34, s33
    buffer_load_dwordx4 v7, s[16:19], s32 offen offset:0 lds
    buffer_load_dwordx4 v8, s[16:19], s32 offen offset:1024 lds
    s_mul_i32 s33, s42, 172032
    s_add_u32 m0, s36, 8192
    s_add_u32 s32, s34, s33
    buffer_load_dwordx4 v7, s[16:19], s32 offen offset:0 lds
    buffer_load_dwordx4 v8, s[16:19], s32 offen offset:1024 lds
    s_waitcnt vmcnt(4)
    s_barrier
    s_mul_i32 s33, s43, 172032
    s_add_u32 m0, s36, 16384
    s_add_u32 s32, s34, s33
    buffer_load_dwordx4 v7, s[16:19], s32 offen offset:0 lds
    buffer_load_dwordx4 v8, s[16:19], s32 offen offset:1024 lds
    s_waitcnt vmcnt(2)
    s_barrier
    s_mul_i32 s33, s37, 229376
    s_add_u32 s33, s33, s30
    s_add_u32 s33, s33, 1536
    s_add_u32 m0, s36, 32768
    s_nop 0
    buffer_load_dwordx4 v5, s[8:11], s33 offen offset:0 lds
    buffer_load_dwordx4 v6, s[8:11], s33 offen offset:1024 lds
    s_add_u32 m0, s36, 40960
    s_nop 0
    buffer_load_dwordx4 v5, s[12:15], s33 offen offset:0 lds
    buffer_load_dwordx4 v6, s[12:15], s33 offen offset:1024 lds
    s_waitcnt vmcnt(4)
    s_barrier
    s_mul_i32 s33, s38, 229376
    s_add_u32 s33, s33, s30
    s_add_u32 s33, s33, 1536
    s_add_u32 m0, s36, 0
    s_nop 0
    buffer_load_dwordx4 v5, s[8:11], s33 offen offset:0 lds
    buffer_load_dwordx4 v6, s[8:11], s33 offen offset:1024 lds
    s_add_u32 m0, s36, 8192
    s_nop 0
    buffer_load_dwordx4 v5, s[12:15], s33 offen offset:0 lds
    buffer_load_dwordx4 v6, s[12:15], s33 offen offset:1024 lds
    s_waitcnt vmcnt(4)
    s_barrier
    s_mul_i32 s33, s39, 229376
    s_add_u32 s33, s33, s30
    s_add_u32 s33, s33, 1536
    s_add_u32 m0, s36, 16384
    s_nop 0
    buffer_load_dwordx4 v5, s[8:11], s33 offen offset:0 lds
    buffer_load_dwordx4 v6, s[8:11], s33 offen offset:1024 lds
    s_add_u32 m0, s36, 24576
    s_nop 0
    buffer_load_dwordx4 v5, s[12:15], s33 offen offset:0 lds
    buffer_load_dwordx4 v6, s[12:15], s33 offen offset:1024 lds
    s_waitcnt vmcnt(4)
    s_barrier
    s_mul_i32 s33, s40, 229376
    s_add_u32 s33, s33, s30
    s_add_u32 s33, s33, 1536
    s_add_u32 m0, s36, 32768
    s_nop 0
    buffer_load_dwordx4 v5, s[8:11], s33 offen offset:0 lds
    buffer_load_dwordx4 v6, s[8:11], s33 offen offset:1024 lds
    s_add_u32 m0, s36, 40960
    s_nop 0
    buffer_load_dwordx4 v5, s[12:15], s33 offen offset:0 lds
    buffer_load_dwordx4 v6, s[12:15], s33 offen offset:1024 lds
    s_waitcnt vmcnt(4)
    s_barrier
    s_mul_i32 s33, s41, 229376
    s_add_u32 s33, s33, s30
    s_add_u32 s33, s33, 1536
    s_add_u32 m0, s36, 0
    s_nop 0
    buffer_load_dwordx4 v5, s[8:11], s33 offen offset:0 lds
    buffer_load_dwordx4 v6, s[8:11], s33 offen offset:1024 lds
    s_add_u32 m0, s36, 8192
    s_nop 0
    buffer_load_dwordx4 v5, s[12:15], s33 offen offset:0 lds
    buffer_load_dwordx4 v6, s[12:15], s33 offen offset:1024 lds
    s_lshl_b32 s32, s26, 4
    s_add_u32 s32, s32, s25
    s_lshl_b32 s32, s32, 7
    s_add_u32 s32, s32, 18939904
    s_min_u32 s33, s28, 1
    s_lshl_b32 s33, s33, 19
    s_add_u32 s32, s32, s33
    v_mov_b32 v9, s27
    v_mov_b32 v249, 0
    s_mov_b64 exec, 1
    buffer_store_dword v9, v249, s[20:23], s32 offen offset:0 sc1
    s_mov_b64 exec, -1
    s_waitcnt vmcnt(5)
    s_barrier
    s_mul_i32 s33, s42, 229376
    s_add_u32 s33, s33, s30
    s_add_u32 s33, s33, 1536
    s_add_u32 m0, s36, 16384
    s_nop 0
    buffer_load_dwordx4 v5, s[8:11], s33 offen offset:0 lds
    buffer_load_dwordx4 v6, s[8:11], s33 offen offset:1024 lds
    s_add_u32 m0, s36, 24576
    s_nop 0
    buffer_load_dwordx4 v5, s[12:15], s33 offen offset:0 lds
    buffer_load_dwordx4 v6, s[12:15], s33 offen offset:1024 lds
    s_waitcnt vmcnt(5)
    s_barrier
    s_mul_i32 s33, s43, 229376
    s_add_u32 s33, s33, s30
    s_add_u32 s33, s33, 1536
    s_add_u32 m0, s36, 32768
    s_nop 0
    buffer_load_dwordx4 v5, s[8:11], s33 offen offset:0 lds
    buffer_load_dwordx4 v6, s[8:11], s33 offen offset:1024 lds
    s_add_u32 m0, s36, 40960
    s_nop 0
    buffer_load_dwordx4 v5, s[12:15], s33 offen offset:0 lds
    buffer_load_dwordx4 v6, s[12:15], s33 offen offset:1024 lds
    s_lshl_b32 s32, s68, 4
    s_add_u32 s33, s32, 128
    v_add_u32 v14, s33, v253
    s_lshr_b32 s33, s68, 1
    s_lshl_b32 s33, s33, 4
    s_add_u32 s33, s33, 176
    v_add_u32 v250, s33, v253
    v_cmp_le_u32 vcc, 16, v253
    s_nop 1
    v_cndmask_b32 v14, v14, v250, vcc
    s_and_b32 s33, s69, 15
    s_add_u32 s32, s32, s33
    v_mov_b32 v250, s32
    v_cmp_le_u32 vcc, 32, v253
    s_nop 1
    v_cndmask_b32 v14, v14, v250, vcc
    v_lshlrev_b32 v14, 7, v14
    s_waitcnt vmcnt(4)
    s_barrier
L_k12_help2:
    s_lshr_b32 s32, s69, 4
    s_lshl_b32 s29, s68, 1
    s_add_u32 s29, s29, s32
    s_and_b32 s30, s69, 15
    s_lshl_b32 s35, s28, 12
    s_lshl_b32 s34, s29, 18
    s_add_u32 s34, s34, 2097152
    s_add_u32 s34, s34, s35
    s_mul_i32 s32, s69, 37
    s_lshr_b32 s32, s32, 8
    s_mul_i32 s33, s32, 7
    s_sub_u32 s37, s69, s33
    s_lshl_b32 s36, s68, 2
    s_add_u32 s36, s36, s32
    s_min_u32 s36, s36, 31
    s_cmp_eq_u32 s28, 1
    s_mov_b32 s33, 0x40000000
    s_cselect_b32 s32, 18939904, s33
    buffer_load_dword v15, v14, s[20:23], s32 offen sc1
    s_mov_b32 s64, s84
    s_mov_b32 s65, s85
    s_mov_b32 s66, 1605632
    s_mov_b32 s67, 0x20000
    v_lshrrev_b32 v250, 3, v253
    v_bfe_u32 v251, v253, 2, 1
    v_bfe_u32 v252, v253, 4, 1
    v_xor_b32 v251, v251, v252
    v_mul_u32_u24 v2, 896, v250
    v_lshl_add_u32 v2, v251, 6, v2
    v_and_b32 v251, 3, v253
    v_lshl_add_u32 v2, v251, 4, v2
    v_add_u32 v3, 6144, v2
    v_add_u32 v4, 12288, v2
    v_add_u32 v5, 18432, v2
    s_lshl_b32 s38, s28, 14
    s_add_u32 s38, s38, 65536
    s_mul_i32 s39, s28, 172032
    s_lshl_b32 s32, s37, 7
    s_add_u32 s39, s39, s32
    s_lshl_b32 s32, s28, 1
    s_add_u32 s32, s32, 18
    s_mul_i32 s42, s32, 28672
    s_add_u32 s42, s42, s39
    s_lshl_b32 s43, s32, 11
    s_mul_i32 s40, s36, 229376
    s_mul_i32 s32, s28, 12288
    s_add_u32 s40, s40, s32
    s_add_u32 s40, s40, 6291456
    s_add_u32 s43, s43, s40
    v_lshrrev_b32 v251, 5, v253
    v_bfe_u32 v250, v253, 2, 2
    v_lshl_add_u32 v250, v251, 2, v250
    v_bfe_u32 v252, v253, 4, 1
    v_lshlrev_b32 v252, 5, v252
    v_and_b32 v251, 3, v253
    v_lshl_add_u32 v252, v251, 3, v252
    v_lshl_add_u32 v252, v250, 7, v252
    v_bfe_u32 v251, v253, 3, 1
    v_lshl_add_u32 v6, v251, 6, v252
    v_xor_b32 v7, 64, v6
    v_add_u32 v6, s38, v6
    v_add_u32 v7, s38, v7
    v_add_u32 v11, s38, v254
    s_lshl_b32 s32, s28, 12
    s_add_u32 s32, s32, 65536
    v_add_u32 v12, s32, v254
    s_lshr_b32 s32, s36, 1
    v_and_b32 v250, 15, v253
    v_lshl_add_u32 v13, v250, 4, s32
    v_lshlrev_b32 v13, 7, v13
    v_mov_b32 v8, 49152
    v_not_b32 v9, s27
    ds_write_b32 v8, v9
    s_waitcnt vmcnt(1) lgkmcnt(0)
    s_barrier
    s_setprio 0
    s_cmp_eq_u32 s28, 1
    s_cbranch_scc1 L_k12_pl
    s_cmp_lg_u32 s28, 0
    s_cbranch_scc1 L_k12_wl
    s_lshl_b32 s32, s26, 4
    s_add_u32 s32, s32, s25
    s_lshl_b32 s32, s32, 7
    s_add_u32 s32, s32, 19070976
    s_min_u32 s33, s28, 1
    s_lshl_b32 s33, s33, 19
    s_add_u32 s32, s32, s33
    v_mov_b32 v9, s27
    v_mov_b32 v249, 0
    s_mov_b64 exec, 1
    buffer_store_dword v9, v249, s[20:23], s32 offen offset:0 sc1
    s_mov_b64 exec, -1
L_k12_wl:
    s_mov_b32 s31, 0
L_k12_wl2:
    ds_read_b32 v9, v8
    s_add_u32 s31, s31, 1
    s_waitcnt lgkmcnt(0)
    v_readfirstlane_b32 s33, v9
    s_cmp_gt_u32 s31, 2097152
    s_cbranch_scc1 L_k12_p1ok
    s_cmp_eq_u32 s33, s27
    s_cbranch_scc1 L_k12_p1ok
    s_sleep 2
    s_branch L_k12_wl2
L_k12_pl:
    s_waitcnt vmcnt(0)
    v_cmp_ne_u32 vcc, s27, v15
    s_nop 0
    s_and_b32 s33, vcc_hi, 1
    s_or_b32 s33, s33, vcc_lo
    s_cbranch_scc0 L_k12_p1sig
    s_mov_b32 s32, 18939904
    s_mov_b32 exec_lo, 0xffffffff
    s_mov_b32 exec_hi, 0x1
    s_mov_b32 s31, 0
L_k12_p1:
    buffer_load_dword v15, v14, s[20:23], s32 offen sc1
    s_add_u32 s31, s31, 1
    s_waitcnt vmcnt(0)
    v_cmp_ne_u32 vcc, s27, v15
    s_cmp_gt_u32 s31, 131072
    s_cbranch_scc1 L_k12_p1_out
    s_and_b64 exec, exec, vcc
    s_cbranch_scc0 L_k12_p1_out
    s_sleep 4
    s_branch L_k12_p1
L_k12_p1_out:
    s_mov_b64 exec, -1
L_k12_p1sig:
    v_mov_b32 v9, s27
    ds_write_b32 v8, v9
L_k12_p1ok:
    s_add_u32 m0, s35, 0
    s_add_u32 s32, s34, 0
    buffer_load_dwordx4 v254, s[20:23], s32 offen offset:0 sc1 lds
    buffer_load_dwordx4 v254, s[20:23], s32 offen offset:1024 sc1 lds
    buffer_load_dwordx4 v254, s[20:23], s32 offen offset:2048 sc1 lds
    buffer_load_dwordx4 v254, s[20:23], s32 offen offset:3072 sc1 lds
    s_lshl_b32 s32, s29, 6
    s_lshl_b32 s33, s30, 2
    s_add_u32 s32, s32, s33
    s_add_u32 s32, s32, s28
    s_lshl_b32 s32, s32, 11
    s_lshl_b32 s33, s28, 11
    s_add_u32 m0, s33, 73728
    s_nop 0
    buffer_load_dwordx4 v254, s[20:23], s32 offen offset:0 sc1 lds
    buffer_load_dwordx4 v254, s[20:23], s32 offen offset:1024 sc1 lds
    s_add_u32 m0, s35, 16384
    s_add_u32 s32, s34, 16384
    buffer_load_dwordx4 v254, s[20:23], s32 offen offset:0 sc1 lds
    buffer_load_dwordx4 v254, s[20:23], s32 offen offset:1024 sc1 lds
    buffer_load_dwordx4 v254, s[20:23], s32 offen offset:2048 sc1 lds
    buffer_load_dwordx4 v254, s[20:23], s32 offen offset:3072 sc1 lds
    s_add_u32 m0, s35, 32768
    s_add_u32 s32, s34, 32768
    buffer_load_dwordx4 v254, s[20:23], s32 offen offset:0 sc1 lds
    buffer_load_dwordx4 v254, s[20:23], s32 offen offset:1024 sc1 lds
    buffer_load_dwordx4 v254, s[20:23], s32 offen offset:2048 sc1 lds
    buffer_load_dwordx4 v254, s[20:23], s32 offen offset:3072 sc1 lds
    s_setprio 0
    s_cmp_ge_u32 s69, 28
    s_cbranch_scc1 L_k12_nogemm
    s_waitcnt vmcnt(4)
    s_barrier
    s_add_u32 m0, s35, 49152
    s_add_u32 s32, s34, 49152
    buffer_load_dwordx4 v254, s[20:23], s32 offen offset:0 sc1 lds
    buffer_load_dwordx4 v254, s[20:23], s32 offen offset:1024 sc1 lds
    buffer_load_dwordx4 v254, s[20:23], s32 offen offset:2048 sc1 lds
    buffer_load_dwordx4 v254, s[20:23], s32 offen offset:3072 sc1 lds
    s_mov_b32 s32, 19070976
    buffer_load_dword v8, v13, s[20:23], s32 offen offset:0 sc1
    s_add_u32 m0, s38, 0
    s_add_u32 s31, s39, 0
    buffer_load_dwordx4 v2, s[64:67], s31 offen offset:0 lds
    buffer_load_dwordx4 v3, s[64:67], s31 offen offset:1024 lds
    buffer_load_dwordx4 v4, s[64:67], s31 offen offset:2048 lds
    buffer_load_dwordx4 v5, s[64:67], s31 offen offset:3072 lds
    s_add_u32 m0, s38, 4096
    s_add_u32 s31, s39, 28672
    buffer_load_dwordx4 v2, s[64:67], s31 offen offset:0 lds
    buffer_load_dwordx4 v3, s[64:67], s31 offen offset:1024 lds
    buffer_load_dwordx4 v4, s[64:67], s31 offen offset:2048 lds
    buffer_load_dwordx4 v5, s[64:67], s31 offen offset:3072 lds
    s_waitcnt vmcnt(13)
    s_barrier
    s_add_u32 m0, s35, 0
    s_add_u32 s32, s34, 65536
    buffer_load_dwordx4 v254, s[20:23], s32 offen offset:0 sc1 lds
    buffer_load_dwordx4 v254, s[20:23], s32 offen offset:1024 sc1 lds
    buffer_load_dwordx4 v254, s[20:23], s32 offen offset:2048 sc1 lds
    buffer_load_dwordx4 v254, s[20:23], s32 offen offset:3072 sc1 lds
    s_waitcnt vmcnt(12)
    v_cmp_ne_u32 vcc, s27, v8
    s_nop 0
    s_and_b32 s33, vcc_lo, 0xfff
    s_cbranch_scc0 L_k12_p1bok
    s_mov_b32 s32, 19070976
    s_mov_b32 exec_lo, 0xfff
    s_mov_b32 exec_hi, 0x0
    s_mov_b32 s31, 0
L_k12_p1b:
    buffer_load_dword v8, v13, s[20:23], s32 offen sc1
    s_add_u32 s31, s31, 1
    s_waitcnt vmcnt(0)
    v_cmp_ne_u32 vcc, s27, v8
    s_cmp_gt_u32 s31, 131072
    s_cbranch_scc1 L_k12_p1b_out
    s_and_b64 exec, exec, vcc
    s_cbranch_scc0 L_k12_p1b_out
    s_sleep 4
    s_branch L_k12_p1b
L_k12_p1b_out:
    s_mov_b64 exec, -1
L_k12_p1bok:
    s_add_u32 s33, s40, 0
    buffer_load_dwordx4 v[16:19], v254, s[20:23], s33 offen offset:0 sc1
    s_add_u32 s33, s40, 114688
    buffer_load_dwordx4 v[20:23], v254, s[20:23], s33 offen offset:0 sc1
    s_add_u32 s33, s40, 0
    buffer_load_dwordx4 v[24:27], v254, s[20:23], s33 offen offset:1024 sc1
    s_add_u32 s33, s40, 114688
    buffer_load_dwordx4 v[28:31], v254, s[20:23], s33 offen offset:1024 sc1
    s_add_u32 s33, s40, 2048
    buffer_load_dwordx4 v[32:35], v254, s[20:23], s33 offen offset:0 sc1
    s_add_u32 s33, s40, 116736
    buffer_load_dwordx4 v[36:39], v254, s[20:23], s33 offen offset:0 sc1
    s_add_u32 s33, s40, 2048
    buffer_load_dwordx4 v[40:43], v254, s[20:23], s33 offen offset:1024 sc1
    s_add_u32 s33, s40, 116736
    buffer_load_dwordx4 v[44:47], v254, s[20:23], s33 offen offset:1024 sc1
    s_barrier
    s_add_u32 m0, s35, 16384
    s_add_u32 s32, s34, 81920
    buffer_load_dwordx4 v254, s[20:23], s32 offen offset:0 sc1 lds
    buffer_load_dwordx4 v254, s[20:23], s32 offen offset:1024 sc1 lds
    buffer_load_dwordx4 v254, s[20:23], s32 offen offset:2048 sc1 lds
    buffer_load_dwordx4 v254, s[20:23], s32 offen offset:3072 sc1 lds
    s_lshl_b32 s32, s26, 4
    s_add_u32 s32, s32, s25
    s_lshl_b32 s32, s32, 7
    s_add_u32 s32, s32, 19005440
    s_min_u32 s33, s28, 1
    s_lshl_b32 s33, s33, 19
    s_add_u32 s32, s32, s33
    v_mov_b32 v9, s27
    v_mov_b32 v249, 0
    s_mov_b64 exec, 1
    buffer_store_dword v9, v249, s[20:23], s32 offen offset:0 sc1
    s_mov_b64 exec, -1
    s_waitcnt vmcnt(21)
    ds_read_b64_tr_b16 v[144:145], v6 offset:0
    ds_read_b64_tr_b16 v[146:147], v6 offset:1024
    ds_read_b64_tr_b16 v[148:149], v7 offset:0
    ds_read_b64_tr_b16 v[150:151], v7 offset:1024
    ds_read_b64_tr_b16 v[152:153], v6 offset:2048
    ds_read_b64_tr_b16 v[154:155], v6 offset:3072
    ds_read_b64_tr_b16 v[156:157], v7 offset:2048
    ds_read_b64_tr_b16 v[158:159], v7 offset:3072
    s_add_u32 s33, s40, 4096
    buffer_load_dwordx4 v[48:51], v254, s[20:23], s33 offen offset:0 sc1
    s_waitcnt lgkmcnt(6)
    s_waitcnt vmcnt(13)
    v_mfma_f32_32x32x16_bf16 v[80:95], v[144:147], v[16:19], 0
    s_add_u32 s33, s40, 118784
    buffer_load_dwordx4 v[52:55], v254, s[20:23], s33 offen offset:0 sc1
    s_waitcnt vmcnt(13)
    v_mfma_f32_32x32x16_bf16 v[96:111], v[144:147], v[20:23], 0
    s_add_u32 s33, s40, 4096
    buffer_load_dwordx4 v[56:59], v254, s[20:23], s33 offen offset:1024 sc1
    s_waitcnt lgkmcnt(4)
    v_mfma_f32_32x32x16_bf16 v[112:127], v[148:151], v[16:19], 0
    s_add_u32 s33, s40, 118784
    buffer_load_dwordx4 v[60:63], v254, s[20:23], s33 offen offset:1024 sc1
    v_mfma_f32_32x32x16_bf16 v[128:143], v[148:151], v[20:23], 0
    s_add_u32 m0, s38, 8192
    s_add_u32 s31, s39, 57344
    buffer_load_dwordx4 v2, s[64:67], s31 offen offset:0 lds
    s_waitcnt lgkmcnt(2)
    s_waitcnt vmcnt(15)
    v_mfma_f32_32x32x16_bf16 v[80:95], v[152:155], v[24:27], v[80:95]
    buffer_load_dwordx4 v3, s[64:67], s31 offen offset:1024 lds
    s_waitcnt vmcnt(15)
    v_mfma_f32_32x32x16_bf16 v[96:111], v[152:155], v[28:31], v[96:111]
    buffer_load_dwordx4 v4, s[64:67], s31 offen offset:2048 lds
    s_waitcnt lgkmcnt(0)
    v_mfma_f32_32x32x16_bf16 v[112:127], v[156:159], v[24:27], v[112:127]
    buffer_load_dwordx4 v5, s[64:67], s31 offen offset:3072 lds
    v_mfma_f32_32x32x16_bf16 v[128:143], v[156:159], v[28:31], v[128:143]
    s_barrier
    s_add_u32 m0, s35, 32768
    s_add_u32 s32, s34, 98304
    buffer_load_dwordx4 v254, s[20:23], s32 offen offset:0 sc1 lds
    buffer_load_dwordx4 v254, s[20:23], s32 offen offset:1024 sc1 lds
    buffer_load_dwordx4 v254, s[20:23], s32 offen offset:2048 sc1 lds
    buffer_load_dwordx4 v254, s[20:23], s32 offen offset:3072 sc1 lds
    v_mov_b32 v248, 131136
    v_not_b32 v247, s27
    ds_write_b32 v248, v247 offset:0
    ds_read_b64_tr_b16 v[144:145], v6 offset:4096
    ds_read_b64_tr_b16 v[146:147], v6 offset:5120
    ds_read_b64_tr_b16 v[148:149], v7 offset:4096
    ds_read_b64_tr_b16 v[150:151], v7 offset:5120
    ds_read_b64_tr_b16 v[152:153], v6 offset:6144
    ds_read_b64_tr_b16 v[154:155], v6 offset:7168
    ds_read_b64_tr_b16 v[156:157], v7 offset:6144
    ds_read_b64_tr_b16 v[158:159], v7 offset:7168
    s_add_u32 s33, s40, 6144
    buffer_load_dwordx4 v[64:67], v254, s[20:23], s33 offen offset:0 sc1
    s_waitcnt lgkmcnt(6)
    s_waitcnt vmcnt(21)
    v_mfma_f32_32x32x16_bf16 v[80:95], v[144:147], v[32:35], v[80:95]
    s_add_u32 s33, s40, 120832
    buffer_load_dwordx4 v[68:71], v254, s[20:23], s33 offen offset:0 sc1
    s_waitcnt vmcnt(21)
    v_mfma_f32_32x32x16_bf16 v[96:111], v[144:147], v[36:39], v[96:111]
    s_add_u32 s33, s40, 6144
    buffer_load_dwordx4 v[72:75], v254, s[20:23], s33 offen offset:1024 sc1
    s_waitcnt lgkmcnt(4)
    v_mfma_f32_32x32x16_bf16 v[112:127], v[148:151], v[32:35], v[112:127]
    s_add_u32 s33, s40, 120832
    buffer_load_dwordx4 v[76:79], v254, s[20:23], s33 offen offset:1024 sc1
    v_mfma_f32_32x32x16_bf16 v[128:143], v[148:151], v[36:39], v[128:143]
    s_add_u32 m0, s38, 12288
    s_add_u32 s31, s39, 86016
    buffer_load_dwordx4 v2, s[64:67], s31 offen offset:0 lds
    s_waitcnt lgkmcnt(2)
    s_waitcnt vmcnt(23)
    v_mfma_f32_32x32x16_bf16 v[80:95], v[152:155], v[40:43], v[80:95]
    buffer_load_dwordx4 v3, s[64:67], s31 offen offset:1024 lds
    s_waitcnt vmcnt(23)
    v_mfma_f32_32x32x16_bf16 v[96:111], v[152:155], v[44:47], v[96:111]
    buffer_load_dwordx4 v4, s[64:67], s31 offen offset:2048 lds
    s_waitcnt lgkmcnt(0)
    v_mfma_f32_32x32x16_bf16 v[112:127], v[156:159], v[40:43], v[112:127]
    buffer_load_dwordx4 v5, s[64:67], s31 offen offset:3072 lds
    v_mfma_f32_32x32x16_bf16 v[128:143], v[156:159], v[44:47], v[128:143]
    s_waitcnt vmcnt(21)
    s_barrier
    s_add_u32 m0, s35, 49152
    s_add_u32 s32, s34, 114688
    buffer_load_dwordx4 v254, s[20:23], s32 offen offset:0 sc1 lds
    buffer_load_dwordx4 v254, s[20:23], s32 offen offset:1024 sc1 lds
    buffer_load_dwordx4 v254, s[20:23], s32 offen offset:2048 sc1 lds
    buffer_load_dwordx4 v254, s[20:23], s32 offen offset:3072 sc1 lds
    s_waitcnt vmcnt(16)
    ds_read_b64_tr_b16 v[144:145], v6 offset:8192
    ds_read_b64_tr_b16 v[146:147], v6 offset:9216
    ds_read_b64_tr_b16 v[148:149], v7 offset:8192
    ds_read_b64_tr_b16 v[150:151], v7 offset:9216
    ds_read_b64_tr_b16 v[152:153], v6 offset:10240
    ds_read_b64_tr_b16 v[154:155], v6 offset:11264
    ds_read_b64_tr_b16 v[156:157], v7 offset:10240
    ds_read_b64_tr_b16 v[158:159], v7 offset:11264
    s_add_u32 s33, s40, 8192
    buffer_load_dwordx4 v[16:19], v254, s[20:23], s33 offen offset:0 sc1
    s_waitcnt lgkmcnt(6)
    v_mfma_f32_32x32x16_bf16 v[80:95], v[144:147], v[48:51], v[80:95]
    s_add_u32 s33, s40, 122880
    buffer_load_dwordx4 v[20:23], v254, s[20:23], s33 offen offset:0 sc1
    v_mfma_f32_32x32x16_bf16 v[96:111], v[144:147], v[52:55], v[96:111]
    s_add_u32 s33, s40, 8192
    buffer_load_dwordx4 v[24:27], v254, s[20:23], s33 offen offset:1024 sc1
    s_waitcnt lgkmcnt(4)
    v_mfma_f32_32x32x16_bf16 v[112:127], v[148:151], v[48:51], v[112:127]
    s_add_u32 s33, s40, 122880
    buffer_load_dwordx4 v[28:31], v254, s[20:23], s33 offen offset:1024 sc1
    v_mfma_f32_32x32x16_bf16 v[128:143], v[148:151], v[52:55], v[128:143]
    s_add_u32 m0, s38, 0
    s_add_u32 s31, s39, 114688
    buffer_load_dwordx4 v2, s[64:67], s31 offen offset:0 lds
    s_waitcnt lgkmcnt(2)
    v_mfma_f32_32x32x16_bf16 v[80:95], v[152:155], v[56:59], v[80:95]
    buffer_load_dwordx4 v3, s[64:67], s31 offen offset:1024 lds
    v_mfma_f32_32x32x16_bf16 v[96:111], v[152:155], v[60:63], v[96:111]
    buffer_load_dwordx4 v4, s[64:67], s31 offen offset:2048 lds
    s_waitcnt lgkmcnt(0)
    v_mfma_f32_32x32x16_bf16 v[112:127], v[156:159], v[56:59], v[112:127]
    buffer_load_dwordx4 v5, s[64:67], s31 offen offset:3072 lds
    v_mfma_f32_32x32x16_bf16 v[128:143], v[156:159], v[60:63], v[128:143]
    s_waitcnt vmcnt(20)
    s_barrier
    s_add_u32 m0, s35, 0
    s_add_u32 s32, s34, 131072
    buffer_load_dwordx4 v254, s[20:23], s32 offen offset:0 sc1 lds
    buffer_load_dwordx4 v254, s[20:23], s32 offen offset:1024 sc1 lds
    buffer_load_dwordx4 v254, s[20:23], s32 offen offset:2048 sc1 lds
    buffer_load_dwordx4 v254, s[20:23], s32 offen offset:3072 sc1 lds
    s_mov_b32 s32, 19005440
    buffer_load_dword v8, v13, s[20:23], s32 offen offset:0 sc1
    s_waitcnt vmcnt(17)
    ds_read_b64_tr_b16 v[144:145], v6 offset:12288
    ds_read_b64_tr_b16 v[146:147], v6 offset:13312
    ds_read_b64_tr_b16 v[148:149], v7 offset:12288
    ds_read_b64_tr_b16 v[150:151], v7 offset:13312
    ds_read_b64_tr_b16 v[152:153], v6 offset:14336
    ds_read_b64_tr_b16 v[154:155], v6 offset:15360
    ds_read_b64_tr_b16 v[156:157], v7 offset:14336
    ds_read_b64_tr_b16 v[158:159], v7 offset:15360
    s_add_u32 s33, s40, 10240
    buffer_load_dwordx4 v[32:35], v254, s[20:23], s33 offen offset:0 sc1
    s_waitcnt lgkmcnt(6)
    v_mfma_f32_32x32x16_bf16 v[80:95], v[144:147], v[64:67], v[80:95]
    s_add_u32 s33, s40, 124928
    buffer_load_dwordx4 v[36:39], v254, s[20:23], s33 offen offset:0 sc1
    v_mfma_f32_32x32x16_bf16 v[96:111], v[144:147], v[68:71], v[96:111]
    s_add_u32 s33, s40, 10240
    buffer_load_dwordx4 v[40:43], v254, s[20:23], s33 offen offset:1024 sc1
    s_waitcnt lgkmcnt(4)
    v_mfma_f32_32x32x16_bf16 v[112:127], v[148:151], v[64:67], v[112:127]
    s_add_u32 s33, s40, 124928
    buffer_load_dwordx4 v[44:47], v254, s[20:23], s33 offen offset:1024 sc1
    v_mfma_f32_32x32x16_bf16 v[128:143], v[148:151], v[68:71], v[128:143]
    s_add_u32 m0, s38, 4096
    s_add_u32 s31, s39, 143360
    buffer_load_dwordx4 v2, s[64:67], s31 offen offset:0 lds
    s_waitcnt lgkmcnt(2)
    v_mfma_f32_32x32x16_bf16 v[80:95], v[152:155], v[72:75], v[80:95]
    buffer_load_dwordx4 v3, s[64:67], s31 offen offset:1024 lds
    v_mfma_f32_32x32x16_bf16 v[96:111], v[152:155], v[76:79], v[96:111]
    buffer_load_dwordx4 v4, s[64:67], s31 offen offset:2048 lds
    s_waitcnt lgkmcnt(0)
    v_mfma_f32_32x32x16_bf16 v[112:127], v[156:159], v[72:75], v[112:127]
    buffer_load_dwordx4 v5, s[64:67], s31 offen offset:3072 lds
    v_mfma_f32_32x32x16_bf16 v[128:143], v[156:159], v[76:79], v[128:143]
    s_waitcnt vmcnt(21)
    s_barrier
    s_add_u32 m0, s35, 16384
    s_add_u32 s32, s34, 147456
    buffer_load_dwordx4 v254, s[20:23], s32 offen offset:0 sc1 lds
    buffer_load_dwordx4 v254, s[20:23], s32 offen offset:1024 sc1 lds
    buffer_load_dwordx4 v254, s[20:23], s32 offen offset:2048 sc1 lds
    buffer_load_dwordx4 v254, s[20:23], s32 offen offset:3072 sc1 lds
    s_waitcnt vmcnt(12)
    v_cmp_ne_u32 vcc, s27, v8
    s_nop 0
    s_and_b32 s33, vcc_lo, 0xffff
    s_cbranch_scc0 L_k12_p2ok
    s_mov_b32 s32, 19005440
    s_mov_b32 exec_lo, 0xffff
    s_mov_b32 exec_hi, 0x0
    s_mov_b32 s31, 0
L_k12_p2:
    buffer_load_dword v8, v13, s[20:23], s32 offen sc1
    s_add_u32 s31, s31, 1
    s_waitcnt vmcnt(0)
    v_cmp_ne_u32 vcc, s27, v8
    s_cmp_gt_u32 s31, 131072
    s_cbranch_scc1 L_k12_p2_out
    s_and_b64 exec, exec, vcc
    s_cbranch_scc0 L_k12_p2_out
    s_sleep 4
    s_branch L_k12_p2
L_k12_p2_out:
    s_mov_b64 exec, -1
L_k12_p2ok:
    ds_read_b64_tr_b16 v[144:145], v6 offset:0
    ds_read_b64_tr_b16 v[146:147], v6 offset:1024
    ds_read_b64_tr_b16 v[148:149], v7 offset:0
    ds_read_b64_tr_b16 v[150:151], v7 offset:1024
    ds_read_b64_tr_b16 v[152:153], v6 offset:2048
    ds_read_b64_tr_b16 v[154:155], v6 offset:3072
    ds_read_b64_tr_b16 v[156:157], v7 offset:2048
    ds_read_b64_tr_b16 v[158:159], v7 offset:3072
    s_add_u32 s33, s43, 12288
    buffer_load_dwordx4 v[48:51], v254, s[20:23], s33 offen offset:0 sc1
    s_waitcnt lgkmcnt(6)
    v_mfma_f32_32x32x16_bf16 v[80:95], v[144:147], v[16:19], v[80:95]
    s_add_u32 s33, s43, 126976
    buffer_load_dwordx4 v[52:55], v254, s[20:23], s33 offen offset:0 sc1
    v_mfma_f32_32x32x16_bf16 v[96:111], v[144:147], v[20:23], v[96:111]
    s_add_u32 s33, s43, 12288
    buffer_load_dwordx4 v[56:59], v254, s[20:23], s33 offen offset:1024 sc1
    s_waitcnt lgkmcnt(4)
    v_mfma_f32_32x32x16_bf16 v[112:127], v[148:151], v[16:19], v[112:127]
    s_add_u32 s33, s43, 126976
    buffer_load_dwordx4 v[60:63], v254, s[20:23], s33 offen offset:1024 sc1
    v_mfma_f32_32x32x16_bf16 v[128:143], v[148:151], v[20:23], v[128:143]
    s_add_u32 m0, s38, 8192
    s_add_u32 s31, s42, 172032
    buffer_load_dwordx4 v2, s[64:67], s31 offen offset:0 lds
    s_waitcnt lgkmcnt(2)
    v_mfma_f32_32x32x16_bf16 v[80:95], v[152:155], v[24:27], v[80:95]
    buffer_load_dwordx4 v3, s[64:67], s31 offen offset:1024 lds
    v_mfma_f32_32x32x16_bf16 v[96:111], v[152:155], v[28:31], v[96:111]
    buffer_load_dwordx4 v4, s[64:67], s31 offen offset:2048 lds
    s_waitcnt lgkmcnt(0)
    v_mfma_f32_32x32x16_bf16 v[112:127], v[156:159], v[24:27], v[112:127]
    buffer_load_dwordx4 v5, s[64:67], s31 offen offset:3072 lds
    v_mfma_f32_32x32x16_bf16 v[128:143], v[156:159], v[28:31], v[128:143]
    s_barrier
    s_add_u32 m0, s35, 32768
    s_add_u32 s32, s34, 163840
    buffer_load_dwordx4 v254, s[20:23], s32 offen offset:0 sc1 lds
    buffer_load_dwordx4 v254, s[20:23], s32 offen offset:1024 sc1 lds
    buffer_load_dwordx4 v254, s[20:23], s32 offen offset:2048 sc1 lds
    buffer_load_dwordx4 v254, s[20:23], s32 offen offset:3072 sc1 lds
    s_waitcnt vmcnt(16)
    ds_read_b64_tr_b16 v[144:145], v6 offset:4096
    ds_read_b64_tr_b16 v[146:147], v6 offset:5120
    ds_read_b64_tr_b16 v[148:149], v7 offset:4096
    ds_read_b64_tr_b16 v[150:151], v7 offset:5120
    ds_read_b64_tr_b16 v[152:153], v6 offset:6144
    ds_read_b64_tr_b16 v[154:155], v6 offset:7168
    ds_read_b64_tr_b16 v[156:157], v7 offset:6144
    ds_read_b64_tr_b16 v[158:159], v7 offset:7168
    s_add_u32 s33, s43, 14336
    buffer_load_dwordx4 v[64:67], v254, s[20:23], s33 offen offset:0 sc1
    s_waitcnt lgkmcnt(6)
    v_mfma_f32_32x32x16_bf16 v[80:95], v[144:147], v[32:35], v[80:95]
    s_add_u32 s33, s43, 129024
    buffer_load_dwordx4 v[68:71], v254, s[20:23], s33 offen offset:0 sc1
    v_mfma_f32_32x32x16_bf16 v[96:111], v[144:147], v[36:39], v[96:111]
    s_add_u32 s33, s43, 14336
    buffer_load_dwordx4 v[72:75], v254, s[20:23], s33 offen offset:1024 sc1
    s_waitcnt lgkmcnt(4)
    v_mfma_f32_32x32x16_bf16 v[112:127], v[148:151], v[32:35], v[112:127]
    s_add_u32 s33, s43, 129024
    buffer_load_dwordx4 v[76:79], v254, s[20:23], s33 offen offset:1024 sc1
    v_mfma_f32_32x32x16_bf16 v[128:143], v[148:151], v[36:39], v[128:143]
    s_add_u32 m0, s38, 12288
    s_add_u32 s31, s42, 200704
    buffer_load_dwordx4 v2, s[64:67], s31 offen offset:0 lds
    s_waitcnt lgkmcnt(2)
    v_mfma_f32_32x32x16_bf16 v[80:95], v[152:155], v[40:43], v[80:95]
    buffer_load_dwordx4 v3, s[64:67], s31 offen offset:1024 lds
    v_mfma_f32_32x32x16_bf16 v[96:111], v[152:155], v[44:47], v[96:111]
    buffer_load_dwordx4 v4, s[64:67], s31 offen offset:2048 lds
    s_waitcnt lgkmcnt(0)
    v_mfma_f32_32x32x16_bf16 v[112:127], v[156:159], v[40:43], v[112:127]
    buffer_load_dwordx4 v5, s[64:67], s31 offen offset:3072 lds
    v_mfma_f32_32x32x16_bf16 v[128:143], v[156:159], v[44:47], v[128:143]
    s_waitcnt vmcnt(20)
    s_barrier
    s_add_u32 m0, s35, 49152
    s_add_u32 s32, s34, 180224
    buffer_load_dwordx4 v254, s[20:23], s32 offen offset:0 sc1 lds
    buffer_load_dwordx4 v254, s[20:23], s32 offen offset:1024 sc1 lds
    buffer_load_dwordx4 v254, s[20:23], s32 offen offset:2048 sc1 lds
    buffer_load_dwordx4 v254, s[20:23], s32 offen offset:3072 sc1 lds
    s_waitcnt vmcnt(16)
    ds_read_b64_tr_b16 v[144:145], v6 offset:8192
    ds_read_b64_tr_b16 v[146:147], v6 offset:9216
    ds_read_b64_tr_b16 v[148:149], v7 offset:8192
    ds_read_b64_tr_b16 v[150:151], v7 offset:9216
    ds_read_b64_tr_b16 v[152:153], v6 offset:10240
    ds_read_b64_tr_b16 v[154:155], v6 offset:11264
    ds_read_b64_tr_b16 v[156:157], v7 offset:10240
    ds_read_b64_tr_b16 v[158:159], v7 offset:11264
    s_add_u32 s33, s43, 16384
    buffer_load_dwordx4 v[16:19], v254, s[20:23], s33 offen offset:0 sc1
    s_waitcnt lgkmcnt(6)
    v_mfma_f32_32x32x16_bf16 v[80:95], v[144:147], v[48:51], v[80:95]
    s_add_u32 s33, s43, 131072
    buffer_load_dwordx4 v[20:23], v254, s[20:23], s33 offen offset:0 sc1
    v_mfma_f32_32x32x16_bf16 v[96:111], v[144:147], v[52:55], v[96:111]
    s_add_u32 s33, s43, 16384
    buffer_load_dwordx4 v[24:27], v254, s[20:23], s33 offen offset:1024 sc1
    s_waitcnt lgkmcnt(4)
    v_mfma_f32_32x32x16_bf16 v[112:127], v[148:151], v[48:51], v[112:127]
    s_add_u32 s33, s43, 131072
    buffer_load_dwordx4 v[28:31], v254, s[20:23], s33 offen offset:1024 sc1
    v_mfma_f32_32x32x16_bf16 v[128:143], v[148:151], v[52:55], v[128:143]
    s_add_u32 m0, s38, 0
    s_add_u32 s31, s42, 229376
    buffer_load_dwordx4 v2, s[64:67], s31 offen offset:0 lds
    s_waitcnt lgkmcnt(2)
    v_mfma_f32_32x32x16_bf16 v[80:95], v[152:155], v[56:59], v[80:95]
    buffer_load_dwordx4 v3, s[64:67], s31 offen offset:1024 lds
    v_mfma_f32_32x32x16_bf16 v[96:111], v[152:155], v[60:63], v[96:111]
    buffer_load_dwordx4 v4, s[64:67], s31 offen offset:2048 lds
    s_waitcnt lgkmcnt(0)
    v_mfma_f32_32x32x16_bf16 v[112:127], v[156:159], v[56:59], v[112:127]
    buffer_load_dwordx4 v5, s[64:67], s31 offen offset:3072 lds
    v_mfma_f32_32x32x16_bf16 v[128:143], v[156:159], v[60:63], v[128:143]
    s_waitcnt vmcnt(20)
    s_barrier
    s_add_u32 m0, s35, 0
    s_add_u32 s32, s34, 196608
    buffer_load_dwordx4 v254, s[20:23], s32 offen offset:0 sc1 lds
    buffer_load_dwordx4 v254, s[20:23], s32 offen offset:1024 sc1 lds
    buffer_load_dwordx4 v254, s[20:23], s32 offen offset:2048 sc1 lds
    buffer_load_dwordx4 v254, s[20:23], s32 offen offset:3072 sc1 lds
    s_waitcnt vmcnt(16)
    ds_read_b64_tr_b16 v[144:145], v6 offset:12288
    ds_read_b64_tr_b16 v[146:147], v6 offset:13312
    ds_read_b64_tr_b16 v[148:149], v7 offset:12288
    ds_read_b64_tr_b16 v[150:151], v7 offset:13312
    ds_read_b64_tr_b16 v[152:153], v6 offset:14336
    ds_read_b64_tr_b16 v[154:155], v6 offset:15360
    ds_read_b64_tr_b16 v[156:157], v7 offset:14336
    ds_read_b64_tr_b16 v[158:159], v7 offset:15360
    s_add_u32 s33, s43, 18432
    buffer_load_dwordx4 v[32:35], v254, s[20:23], s33 offen offset:0 sc1
    s_waitcnt lgkmcnt(6)
    v_mfma_f32_32x32x16_bf16 v[80:95], v[144:147], v[64:67], v[80:95]
    s_add_u32 s33, s43, 133120
    buffer_load_dwordx4 v[36:39], v254, s[20:23], s33 offen offset:0 sc1
    v_mfma_f32_32x32x16_bf16 v[96:111], v[144:147], v[68:71], v[96:111]
    s_add_u32 s33, s43, 18432
    buffer_load_dwordx4 v[40:43], v254, s[20:23], s33 offen offset:1024 sc1
    s_waitcnt lgkmcnt(4)
    v_mfma_f32_32x32x16_bf16 v[112:127], v[148:151], v[64:67], v[112:127]
    s_add_u32 s33, s43, 133120
    buffer_load_dwordx4 v[44:47], v254, s[20:23], s33 offen offset:1024 sc1
    v_mfma_f32_32x32x16_bf16 v[128:143], v[148:151], v[68:71], v[128:143]
    s_add_u32 m0, s38, 4096
    s_add_u32 s31, s42, 258048
    buffer_load_dwordx4 v2, s[64:67], s31 offen offset:0 lds
    s_waitcnt lgkmcnt(2)
    v_mfma_f32_32x32x16_bf16 v[80:95], v[152:155], v[72:75], v[80:95]
    buffer_load_dwordx4 v3, s[64:67], s31 offen offset:1024 lds
    v_mfma_f32_32x32x16_bf16 v[96:111], v[152:155], v[76:79], v[96:111]
    buffer_load_dwordx4 v4, s[64:67], s31 offen offset:2048 lds
    s_waitcnt lgkmcnt(0)
    v_mfma_f32_32x32x16_bf16 v[112:127], v[156:159], v[72:75], v[112:127]
    buffer_load_dwordx4 v5, s[64:67], s31 offen offset:3072 lds
    v_mfma_f32_32x32x16_bf16 v[128:143], v[156:159], v[76:79], v[128:143]
    s_waitcnt vmcnt(20)
    s_barrier
    s_add_u32 m0, s35, 16384
    s_add_u32 s32, s34, 212992
    buffer_load_dwordx4 v254, s[20:23], s32 offen offset:0 sc1 lds
    buffer_load_dwordx4 v254, s[20:23], s32 offen offset:1024 sc1 lds
    buffer_load_dwordx4 v254, s[20:23], s32 offen offset:2048 sc1 lds
    buffer_load_dwordx4 v254, s[20:23], s32 offen offset:3072 sc1 lds
    s_waitcnt vmcnt(16)
    ds_read_b64_tr_b16 v[144:145], v6 offset:0
    ds_read_b64_tr_b16 v[146:147], v6 offset:1024
    ds_read_b64_tr_b16 v[148:149], v7 offset:0
    ds_read_b64_tr_b16 v[150:151], v7 offset:1024
    ds_read_b64_tr_b16 v[152:153], v6 offset:2048
    ds_read_b64_tr_b16 v[154:155], v6 offset:3072
    ds_read_b64_tr_b16 v[156:157], v7 offset:2048
    ds_read_b64_tr_b16 v[158:159], v7 offset:3072
    s_add_u32 s33, s43, 20480
    buffer_load_dwordx4 v[48:51], v254, s[20:23], s33 offen offset:0 sc1
    s_waitcnt lgkmcnt(6)
    v_mfma_f32_32x32x16_bf16 v[80:95], v[144:147], v[16:19], v[80:95]
    s_add_u32 s33, s43, 135168
    buffer_load_dwordx4 v[52:55], v254, s[20:23], s33 offen offset:0 sc1
    v_mfma_f32_32x32x16_bf16 v[96:111], v[144:147], v[20:23], v[96:111]
    s_add_u32 s33, s43, 20480
    buffer_load_dwordx4 v[56:59], v254, s[20:23], s33 offen offset:1024 sc1
    s_waitcnt lgkmcnt(4)
    v_mfma_f32_32x32x16_bf16 v[112:127], v[148:151], v[16:19], v[112:127]
    s_add_u32 s33, s43, 135168
    buffer_load_dwordx4 v[60:63], v254, s[20:23], s33 offen offset:1024 sc1
    v_mfma_f32_32x32x16_bf16 v[128:143], v[148:151], v[20:23], v[128:143]
    s_add_u32 m0, s38, 8192
    s_add_u32 s31, s42, 286720
    buffer_load_dwordx4 v2, s[64:67], s31 offen offset:0 lds
    s_waitcnt lgkmcnt(2)
    v_mfma_f32_32x32x16_bf16 v[80:95], v[152:155], v[24:27], v[80:95]
    buffer_load_dwordx4 v3, s[64:67], s31 offen offset:1024 lds
    v_mfma_f32_32x32x16_bf16 v[96:111], v[152:155], v[28:31], v[96:111]
    buffer_load_dwordx4 v4, s[64:67], s31 offen offset:2048 lds
    s_waitcnt lgkmcnt(0)
    v_mfma_f32_32x32x16_bf16 v[112:127], v[156:159], v[24:27], v[112:127]
    buffer_load_dwordx4 v5, s[64:67], s31 offen offset:3072 lds
    v_mfma_f32_32x32x16_bf16 v[128:143], v[156:159], v[28:31], v[128:143]
    s_waitcnt vmcnt(20)
    s_barrier
    s_add_u32 m0, s35, 32768
    s_add_u32 s32, s34, 229376
    buffer_load_dwordx4 v254, s[20:23], s32 offen offset:0 sc1 lds
    buffer_load_dwordx4 v254, s[20:23], s32 offen offset:1024 sc1 lds
    buffer_load_dwordx4 v254, s[20:23], s32 offen offset:2048 sc1 lds
    buffer_load_dwordx4 v254, s[20:23], s32 offen offset:3072 sc1 lds
    s_waitcnt vmcnt(16)
    ds_read_b64_tr_b16 v[144:145], v6 offset:4096
    ds_read_b64_tr_b16 v[146:147], v6 offset:5120
    ds_read_b64_tr_b16 v[148:149], v7 offset:4096
    ds_read_b64_tr_b16 v[150:151], v7 offset:5120
    ds_read_b64_tr_b16 v[152:153], v6 offset:6144
    ds_read_b64_tr_b16 v[154:155], v6 offset:7168
    ds_read_b64_tr_b16 v[156:157], v7 offset:6144
    ds_read_b64_tr_b16 v[158:159], v7 offset:7168
    s_add_u32 s33, s43, 22528
    buffer_load_dwordx4 v[64:67], v254, s[20:23], s33 offen offset:0 sc1
    s_waitcnt lgkmcnt(6)
    v_mfma_f32_32x32x16_bf16 v[80:95], v[144:147], v[32:35], v[80:95]
    s_add_u32 s33, s43, 137216
    buffer_load_dwordx4 v[68:71], v254, s[20:23], s33 offen offset:0 sc1
    v_mfma_f32_32x32x16_bf16 v[96:111], v[144:147], v[36:39], v[96:111]
    s_add_u32 s33, s43, 22528
    buffer_load_dwordx4 v[72:75], v254, s[20:23], s33 offen offset:1024 sc1
    s_waitcnt lgkmcnt(4)
    v_mfma_f32_32x32x16_bf16 v[112:127], v[148:151], v[32:35], v[112:127]
    s_add_u32 s33, s43, 137216
    buffer_load_dwordx4 v[76:79], v254, s[20:23], s33 offen offset:1024 sc1
    v_mfma_f32_32x32x16_bf16 v[128:143], v[148:151], v[36:39], v[128:143]
    s_add_u32 m0, s38, 12288
    s_add_u32 s31, s42, 315392
    buffer_load_dwordx4 v2, s[64:67], s31 offen offset:0 lds
    s_waitcnt lgkmcnt(2)
    v_mfma_f32_32x32x16_bf16 v[80:95], v[152:155], v[40:43], v[80:95]
    buffer_load_dwordx4 v3, s[64:67], s31 offen offset:1024 lds
    v_mfma_f32_32x32x16_bf16 v[96:111], v[152:155], v[44:47], v[96:111]
    buffer_load_dwordx4 v4, s[64:67], s31 offen offset:2048 lds
    s_waitcnt lgkmcnt(0)
    v_mfma_f32_32x32x16_bf16 v[112:127], v[156:159], v[40:43], v[112:127]
    buffer_load_dwordx4 v5, s[64:67], s31 offen offset:3072 lds
    v_mfma_f32_32x32x16_bf16 v[128:143], v[156:159], v[44:47], v[128:143]
    s_waitcnt vmcnt(20)
    s_barrier
    s_add_u32 m0, s35, 49152
    s_add_u32 s32, s34, 245760
    buffer_load_dwordx4 v254, s[20:23], s32 offen offset:0 sc1 lds
    buffer_load_dwordx4 v254, s[20:23], s32 offen offset:1024 sc1 lds
    buffer_load_dwordx4 v254, s[20:23], s32 offen offset:2048 sc1 lds
    buffer_load_dwordx4 v254, s[20:23], s32 offen offset:3072 sc1 lds
    s_add_u32 s33, s43, 24576
    buffer_load_dwordx4 v[16:19], v254, s[20:23], s33 offen offset:0 sc1
    s_add_u32 s33, s43, 139264
    buffer_load_dwordx4 v[20:23], v254, s[20:23], s33 offen offset:0 sc1
    s_add_u32 s33, s43, 24576
    buffer_load_dwordx4 v[24:27], v254, s[20:23], s33 offen offset:1024 sc1
    s_add_u32 s33, s43, 139264
    buffer_load_dwordx4 v[28:31], v254, s[20:23], s33 offen offset:1024 sc1
    s_add_u32 m0, s38, 0
    s_add_u32 s31, s42, 344064
    buffer_load_dwordx4 v2, s[64:67], s31 offen offset:0 lds
    buffer_load_dwordx4 v3, s[64:67], s31 offen offset:1024 lds
    buffer_load_dwordx4 v4, s[64:67], s31 offen offset:2048 lds
    buffer_load_dwordx4 v5, s[64:67], s31 offen offset:3072 lds
    s_waitcnt vmcnt(20)
    s_barrier
    s_add_u32 s33, s43, 26624
    buffer_load_dwordx4 v[32:35], v254, s[20:23], s33 offen offset:0 sc1
    s_add_u32 s33, s43, 141312
    buffer_load_dwordx4 v[36:39], v254, s[20:23], s33 offen offset:0 sc1
    s_add_u32 s33, s43, 26624
    buffer_load_dwordx4 v[40:43], v254, s[20:23], s33 offen offset:1024 sc1
    s_add_u32 s33, s43, 141312
    buffer_load_dwordx4 v[44:47], v254, s[20:23], s33 offen offset:1024 sc1
    s_add_u32 m0, s38, 4096
    s_add_u32 s31, s42, 372736
    buffer_load_dwordx4 v2, s[64:67], s31 offen offset:0 lds
    buffer_load_dwordx4 v3, s[64:67], s31 offen offset:1024 lds
    buffer_load_dwordx4 v4, s[64:67], s31 offen offset:2048 lds
    buffer_load_dwordx4 v5, s[64:67], s31 offen offset:3072 lds
    s_waitcnt vmcnt(16)
    s_mov_b32 s8, s76
    s_mov_b32 s9, s77
    s_mov_b32 s10, 401408
    s_mov_b32 s11, 0x20000
    s_mul_i32 s33, s28, 28672
    s_lshl_b32 s32, s37, 7
    s_add_u32 s33, s33, s32
    s_lshl_b32 s31, s28, 12
    s_add_u32 m0, s31, 0
    s_add_u32 s32, s33, 0
    buffer_load_dwordx4 v2, s[8:11], s32 offen offset:0 lds
    buffer_load_dwordx4 v3, s[8:11], s32 offen offset:1024 lds
    buffer_load_dwordx4 v4, s[8:11], s32 offen offset:2048 lds
    buffer_load_dwordx4 v5, s[8:11], s32 offen offset:3072 lds
    s_barrier
    s_mul_i32 s33, s28, 28672
    s_lshl_b32 s32, s37, 7
    s_add_u32 s33, s33, s32
    s_lshl_b32 s31, s28, 12
    s_add_u32 m0, s31, 16384
    s_add_u32 s32, s33, 114688
    buffer_load_dwordx4 v2, s[8:11], s32 offen offset:0 lds
    buffer_load_dwordx4 v3, s[8:11], s32 offen offset:1024 lds
    buffer_load_dwordx4 v4, s[8:11], s32 offen offset:2048 lds
    buffer_load_dwordx4 v5, s[8:11], s32 offen offset:3072 lds
    s_barrier
    s_mul_i32 s33, s28, 28672
    s_lshl_b32 s32, s37, 7
    s_add_u32 s33, s33, s32
    s_lshl_b32 s31, s28, 12
    s_add_u32 m0, s31, 32768
    s_add_u32 s32, s33, 229376
    buffer_load_dwordx4 v2, s[8:11], s32 offen offset:0 lds
    buffer_load_dwordx4 v3, s[8:11], s32 offen offset:1024 lds
    buffer_load_dwordx4 v4, s[8:11], s32 offen offset:2048 lds
    buffer_load_dwordx4 v5, s[8:11], s32 offen offset:3072 lds
    s_barrier
    s_barrier
    s_mul_i32 s33, s28, 28672
    s_lshl_b32 s32, s37, 7
    s_add_u32 s33, s33, s32
    s_lshl_b32 s31, s28, 12
    s_add_u32 m0, s31, 49152
    s_add_u32 s32, s33, 344064
    buffer_load_dwordx4 v2, s[8:11], s32 offen offset:0 lds
    buffer_load_dwordx4 v3, s[8:11], s32 offen offset:1024 lds
    buffer_load_dwordx4 v4, s[8:11], s32 offen offset:2048 lds
    buffer_load_dwordx4 v5, s[8:11], s32 offen offset:3072 lds
    s_waitcnt vmcnt(0)
    s_setprio 3
    s_barrier
    s_lshl_b32 s32, s30, 4
    s_add_u32 s32, s32, s29
    s_lshl_b32 s32, s32, 7
    s_add_u32 s32, s32, 19202048
    s_min_u32 s33, s28, 1
    s_lshl_b32 s33, s33, 19
    s_add_u32 s32, s32, s33
    v_mov_b32 v9, s27
    v_mov_b32 v249, 0
    s_mov_b64 exec, 1
    buffer_store_dword v9, v249, s[20:23], s32 offen offset:0 sc1
    s_mov_b64 exec, -1
    ds_read_b64_tr_b16 v[144:145], v6 offset:8192
    ds_read_b64_tr_b16 v[146:147], v6 offset:9216
    ds_read_b64_tr_b16 v[148:149], v7 offset:8192
    ds_read_b64_tr_b16 v[150:151], v7 offset:9216
    ds_read_b64_tr_b16 v[152:153], v6 offset:10240
    ds_read_b64_tr_b16 v[154:155], v6 offset:11264
    ds_read_b64_tr_b16 v[156:157], v7 offset:10240
    ds_read_b64_tr_b16 v[158:159], v7 offset:11264
    s_waitcnt lgkmcnt(6)
    v_mfma_f32_32x32x16_bf16 v[80:95], v[144:147], v[48:51], v[80:95]
    v_mfma_f32_32x32x16_bf16 v[96:111], v[144:147], v[52:55], v[96:111]
    s_waitcnt lgkmcnt(4)
    v_mfma_f32_32x32x16_bf16 v[112:127], v[148:151], v[48:51], v[112:127]
    v_mfma_f32_32x32x16_bf16 v[128:143], v[148:151], v[52:55], v[128:143]
    s_waitcnt lgkmcnt(2)
    v_mfma_f32_32x32x16_bf16 v[80:95], v[152:155], v[56:59], v[80:95]
    v_mfma_f32_32x32x16_bf16 v[96:111], v[152:155], v[60:63], v[96:111]
    s_waitcnt lgkmcnt(0)
    v_mfma_f32_32x32x16_bf16 v[112:127], v[156:159], v[56:59], v[112:127]
    v_mfma_f32_32x32x16_bf16 v[128:143], v[156:159], v[60:63], v[128:143]
    ds_read_b64_tr_b16 v[144:145], v6 offset:12288
    ds_read_b64_tr_b16 v[146:147], v6 offset:13312
    ds_read_b64_tr_b16 v[148:149], v7 offset:12288
    ds_read_b64_tr_b16 v[150:151], v7 offset:13312
    ds_read_b64_tr_b16 v[152:153], v6 offset:14336
    ds_read_b64_tr_b16 v[154:155], v6 offset:15360
    ds_read_b64_tr_b16 v[156:157], v7 offset:14336
    ds_read_b64_tr_b16 v[158:159], v7 offset:15360
    s_waitcnt lgkmcnt(6)
    v_mfma_f32_32x32x16_bf16 v[80:95], v[144:147], v[64:67], v[80:95]
    v_mfma_f32_32x32x16_bf16 v[96:111], v[144:147], v[68:71], v[96:111]
    s_waitcnt lgkmcnt(4)
    v_mfma_f32_32x32x16_bf16 v[112:127], v[148:151], v[64:67], v[112:127]
    v_mfma_f32_32x32x16_bf16 v[128:143], v[148:151], v[68:71], v[128:143]
    s_waitcnt lgkmcnt(2)
    v_mfma_f32_32x32x16_bf16 v[80:95], v[152:155], v[72:75], v[80:95]
    v_mfma_f32_32x32x16_bf16 v[96:111], v[152:155], v[76:79], v[96:111]
    s_waitcnt lgkmcnt(0)
    v_mfma_f32_32x32x16_bf16 v[112:127], v[156:159], v[72:75], v[112:127]
    v_mfma_f32_32x32x16_bf16 v[128:143], v[156:159], v[76:79], v[128:143]
    ds_read_b64_tr_b16 v[144:145], v6 offset:0
    ds_read_b64_tr_b16 v[146:147], v6 offset:1024
    ds_read_b64_tr_b16 v[148:149], v7 offset:0
    ds_read_b64_tr_b16 v[150:151], v7 offset:1024
    ds_read_b64_tr_b16 v[152:153], v6 offset:2048
    ds_read_b64_tr_b16 v[154:155], v6 offset:3072
    ds_read_b64_tr_b16 v[156:157], v7 offset:2048
    ds_read_b64_tr_b16 v[158:159], v7 offset:3072
    s_waitcnt lgkmcnt(6)
    v_mfma_f32_32x32x16_bf16 v[80:95], v[144:147], v[16:19], v[80:95]
    v_mfma_f32_32x32x16_bf16 v[96:111], v[144:147], v[20:23], v[96:111]
    s_waitcnt lgkmcnt(4)
    v_mfma_f32_32x32x16_bf16 v[112:127], v[148:151], v[16:19], v[112:127]
    v_mfma_f32_32x32x16_bf16 v[128:143], v[148:151], v[20:23], v[128:143]
    s_waitcnt lgkmcnt(2)
    v_mfma_f32_32x32x16_bf16 v[80:95], v[152:155], v[24:27], v[80:95]
    v_mfma_f32_32x32x16_bf16 v[96:111], v[152:155], v[28:31], v[96:111]
    s_waitcnt lgkmcnt(0)
    v_mfma_f32_32x32x16_bf16 v[112:127], v[156:159], v[24:27], v[112:127]
    v_mfma_f32_32x32x16_bf16 v[128:143], v[156:159], v[28:31], v[128:143]
    ds_read_b64_tr_b16 v[144:145], v6 offset:4096
    ds_read_b64_tr_b16 v[146:147], v6 offset:5120
    ds_read_b64_tr_b16 v[148:149], v7 offset:4096
    ds_read_b64_tr_b16 v[150:151], v7 offset:5120
    ds_read_b64_tr_b16 v[152:153], v6 offset:6144
    ds_read_b64_tr_b16 v[154:155], v6 offset:7168
    ds_read_b64_tr_b16 v[156:157], v7 offset:6144
    ds_read_b64_tr_b16 v[158:159], v7 offset:7168
    s_waitcnt lgkmcnt(6)
    v_mfma_f32_32x32x16_bf16 v[80:95], v[144:147], v[32:35], v[80:95]
    v_mfma_f32_32x32x16_bf16 v[96:111], v[144:147], v[36:39], v[96:111]
    s_waitcnt lgkmcnt(4)
    v_mfma_f32_32x32x16_bf16 v[112:127], v[148:151], v[32:35], v[112:127]
    v_mfma_f32_32x32x16_bf16 v[128:143], v[148:151], v[36:39], v[128:143]
    s_waitcnt lgkmcnt(2)
    v_mfma_f32_32x32x16_bf16 v[80:95], v[152:155], v[40:43], v[80:95]
    v_mfma_f32_32x32x16_bf16 v[96:111], v[152:155], v[44:47], v[96:111]
    s_waitcnt lgkmcnt(0)
    v_mfma_f32_32x32x16_bf16 v[112:127], v[156:159], v[40:43], v[112:127]
    v_mfma_f32_32x32x16_bf16 v[128:143], v[156:159], v[44:47], v[128:143]
    s_lshr_b32 s32, s36, 1
    s_lshl_b32 s32, s32, 11
    s_add_u32 s32, s32, 19202048
    v_and_b32 v13, 15, v253
    v_lshlrev_b32 v13, 7, v13
    s_mov_b32 s33, 0x40000000
    s_cmp_eq_u32 s28, 1
    s_cselect_b32 s32, s32, s33
    buffer_load_dword v15, v13, s[20:23], s32 offen offset:0 sc1
    ds_write_b128 v11, v[80:83] offset:0
    ds_write_b128 v11, v[84:87] offset:1024
    ds_write_b128 v11, v[88:91] offset:2048
    ds_write_b128 v11, v[92:95] offset:3072
    ds_write_b128 v11, v[96:99] offset:8192
    ds_write_b128 v11, v[100:103] offset:9216
    ds_write_b128 v11, v[104:107] offset:10240
    ds_write_b128 v11, v[108:111] offset:11264
    ds_write_b128 v11, v[112:115] offset:4096
    ds_write_b128 v11, v[116:119] offset:5120
    ds_write_b128 v11, v[120:123] offset:6144
    ds_write_b128 v11, v[124:127] offset:7168
    ds_write_b128 v11, v[128:131] offset:12288
    ds_write_b128 v11, v[132:135] offset:13312
    ds_write_b128 v11, v[136:139] offset:14336
    ds_write_b128 v11, v[140:143] offset:15360
    s_waitcnt lgkmcnt(0)
    s_barrier
    s_lshr_b32 s32, s36, 1
    s_lshl_b32 s32, s32, 11
    s_add_u32 s32, s32, 19202048
    v_lshlrev_b32 v13, 7, v253
    v_mov_b32 v8, 131136
    s_cmp_lg_u32 s28, 1
    s_cbranch_scc1 L_k12_w3
    s_waitcnt vmcnt(0)
    v_cmp_ne_u32 vcc, s27, v15
    s_nop 0
    s_and_b32 s33, vcc_lo, 0xffff
    s_cbranch_scc0 L_k12_p3sig
    s_mov_b32 exec_lo, 0xffff
    s_mov_b32 exec_hi, 0x0
    s_mov_b32 s31, 0
L_k12_p3:
    buffer_load_dword v15, v13, s[20:23], s32 offen sc1
    s_add_u32 s31, s31, 1
    s_waitcnt vmcnt(0)
    v_cmp_ne_u32 vcc, s27, v15
    s_cmp_gt_u32 s31, 131072
    s_cbranch_scc1 L_k12_p3_out
    s_and_b64 exec, exec, vcc
    s_cbranch_scc0 L_k12_p3_out
    s_sleep 4
    s_branch L_k12_p3
L_k12_p3_out:
    s_mov_b64 exec, -1
L_k12_p3sig:
    v_mov_b32 v9, s27
    ds_write_b32 v8, v9
    s_branch L_k12_p3ok
L_k12_w3:
    s_mov_b32 s31, 0
L_k12_w3b:
    ds_read_b32 v9, v8
    s_add_u32 s31, s31, 1
    s_waitcnt lgkmcnt(0)
    v_readfirstlane_b32 s33, v9
    s_cmp_gt_u32 s31, 2097152
    s_cbranch_scc1 L_k12_p3ok
    s_cmp_eq_u32 s33, s27
    s_cbranch_scc1 L_k12_p3ok
    s_sleep 1
    s_branch L_k12_w3b
L_k12_p3ok:
    s_lshr_b32 s32, s28, 1
    s_lshl_b32 s32, s32, 15
    s_and_b32 s33, s28, 1
    s_lshl_b32 s33, s33, 12
    s_add_u32 s31, s32, s33
    s_lshl_b32 s33, s36, 16
    s_add_u32 s33, s33, s31
    s_add_u32 s33, s33, 16777216
    s_add_u32 m0, s31, 0
    s_add_u32 s32, s33, 0
    buffer_load_dwordx4 v254, s[20:23], s32 offen offset:0 sc1 lds
    buffer_load_dwordx4 v254, s[20:23], s32 offen offset:1024 sc1 lds
    buffer_load_dwordx4 v254, s[20:23], s32 offen offset:2048 sc1 lds
    buffer_load_dwordx4 v254, s[20:23], s32 offen offset:3072 sc1 lds
    s_add_u32 m0, s31, 8192
    s_add_u32 s32, s33, 8192
    buffer_load_dwordx4 v254, s[20:23], s32 offen offset:0 sc1 lds
    buffer_load_dwordx4 v254, s[20:23], s32 offen offset:1024 sc1 lds
    buffer_load_dwordx4 v254, s[20:23], s32 offen offset:2048 sc1 lds
    buffer_load_dwordx4 v254, s[20:23], s32 offen offset:3072 sc1 lds
    s_add_u32 m0, s31, 16384
    s_add_u32 s32, s33, 16384
    buffer_load_dwordx4 v254, s[20:23], s32 offen offset:0 sc1 lds
    buffer_load_dwordx4 v254, s[20:23], s32 offen offset:1024 sc1 lds
    buffer_load_dwordx4 v254, s[20:23], s32 offen offset:2048 sc1 lds
    buffer_load_dwordx4 v254, s[20:23], s32 offen offset:3072 sc1 lds
    s_add_u32 m0, s31, 24576
    s_add_u32 s32, s33, 24576
    buffer_load_dwordx4 v254, s[20:23], s32 offen offset:0 sc1 lds
    buffer_load_dwordx4 v254, s[20:23], s32 offen offset:1024 sc1 lds
    buffer_load_dwordx4 v254, s[20:23], s32 offen offset:2048 sc1 lds
    buffer_load_dwordx4 v254, s[20:23], s32 offen offset:3072 sc1 lds
    s_waitcnt vmcnt(12)
    s_barrier
    s_waitcnt vmcnt(8)
    s_barrier
    s_waitcnt vmcnt(4)
    s_barrier
    s_waitcnt vmcnt(0)
    s_barrier
    s_endpgm
L_k12_nogemm:
    s_waitcnt vmcnt(4)
    s_barrier
    s_add_u32 m0, s35, 49152
    s_add_u32 s32, s34, 49152
    buffer_load_dwordx4 v254, s[20:23], s32 offen offset:0 sc1 lds
    buffer_load_dwordx4 v254, s[20:23], s32 offen offset:1024 sc1 lds
    buffer_load_dwordx4 v254, s[20:23], s32 offen offset:2048 sc1 lds
    buffer_load_dwordx4 v254, s[20:23], s32 offen offset:3072 sc1 lds
    s_waitcnt vmcnt(4)
    s_barrier
    s_add_u32 m0, s35, 0
    s_add_u32 s32, s34, 65536
    buffer_load_dwordx4 v254, s[20:23], s32 offen offset:0 sc1 lds
    buffer_load_dwordx4 v254, s[20:23], s32 offen offset:1024 sc1 lds
    buffer_load_dwordx4 v254, s[20:23], s32 offen offset:2048 sc1 lds
    buffer_load_dwordx4 v254, s[20:23], s32 offen offset:3072 sc1 lds
    s_waitcnt vmcnt(4)
    s_barrier
    s_add_u32 m0, s35, 16384
    s_add_u32 s32, s34, 81920
    buffer_load_dwordx4 v254, s[20:23], s32 offen offset:0 sc1 lds
    buffer_load_dwordx4 v254, s[20:23], s32 offen offset:1024 sc1 lds
    buffer_load_dwordx4 v254, s[20:23], s32 offen offset:2048 sc1 lds
    buffer_load_dwordx4 v254, s[20:23], s32 offen offset:3072 sc1 lds
    s_lshl_b32 s32, s26, 4
    s_add_u32 s32, s32, s25
    s_lshl_b32 s32, s32, 7
    s_add_u32 s32, s32, 19005440
    s_min_u32 s33, s28, 1
    s_lshl_b32 s33, s33, 19
    s_add_u32 s32, s32, s33
    v_mov_b32 v9, s27
    v_mov_b32 v249, 0
    s_mov_b64 exec, 1
    buffer_store_dword v9, v249, s[20:23], s32 offen offset:0 sc1
    s_mov_b64 exec, -1
    s_waitcnt vmcnt(5)
    s_barrier
    s_add_u32 m0, s35, 32768
    s_add_u32 s32, s34, 98304
    buffer_load_dwordx4 v254, s[20:23], s32 offen offset:0 sc1 lds
    buffer_load_dwordx4 v254, s[20:23], s32 offen offset:1024 sc1 lds
    buffer_load_dwordx4 v254, s[20:23], s32 offen offset:2048 sc1 lds
    buffer_load_dwordx4 v254, s[20:23], s32 offen offset:3072 sc1 lds
    s_waitcnt vmcnt(5)
    s_barrier
    s_add_u32 m0, s35, 49152
    s_add_u32 s32, s34, 114688
    buffer_load_dwordx4 v254, s[20:23], s32 offen offset:0 sc1 lds
    buffer_load_dwordx4 v254, s[20:23], s32 offen offset:1024 sc1 lds
    buffer_load_dwordx4 v254, s[20:23], s32 offen offset:2048 sc1 lds
    buffer_load_dwordx4 v254, s[20:23], s32 offen offset:3072 sc1 lds
    s_waitcnt vmcnt(4)
    s_barrier
    s_add_u32 m0, s35, 0
    s_add_u32 s32, s34, 131072
    buffer_load_dwordx4 v254, s[20:23], s32 offen offset:0 sc1 lds
    buffer_load_dwordx4 v254, s[20:23], s32 offen offset:1024 sc1 lds
    buffer_load_dwordx4 v254, s[20:23], s32 offen offset:2048 sc1 lds
    buffer_load_dwordx4 v254, s[20:23], s32 offen offset:3072 sc1 lds
    s_waitcnt vmcnt(4)
    s_barrier
    s_add_u32 m0, s35, 16384
    s_add_u32 s32, s34, 147456
    buffer_load_dwordx4 v254, s[20:23], s32 offen offset:0 sc1 lds
    buffer_load_dwordx4 v254, s[20:23], s32 offen offset:1024 sc1 lds
    buffer_load_dwordx4 v254, s[20:23], s32 offen offset:2048 sc1 lds
    buffer_load_dwordx4 v254, s[20:23], s32 offen offset:3072 sc1 lds
    s_waitcnt vmcnt(4)
    s_barrier
    s_add_u32 m0, s35, 32768
    s_add_u32 s32, s34, 163840
    buffer_load_dwordx4 v254, s[20:23], s32 offen offset:0 sc1 lds
    buffer_load_dwordx4 v254, s[20:23], s32 offen offset:1024 sc1 lds
    buffer_load_dwordx4 v254, s[20:23], s32 offen offset:2048 sc1 lds
    buffer_load_dwordx4 v254, s[20:23], s32 offen offset:3072 sc1 lds
    s_waitcnt vmcnt(4)
    s_barrier
    s_add_u32 m0, s35, 49152
    s_add_u32 s32, s34, 180224
    buffer_load_dwordx4 v254, s[20:23], s32 offen offset:0 sc1 lds
    buffer_load_dwordx4 v254, s[20:23], s32 offen offset:1024 sc1 lds
    buffer_load_dwordx4 v254, s[20:23], s32 offen offset:2048 sc1 lds
    buffer_load_dwordx4 v254, s[20:23], s32 offen offset:3072 sc1 lds
    s_waitcnt vmcnt(4)
    s_barrier
    s_add_u32 m0, s35, 0
    s_add_u32 s32, s34, 196608
    buffer_load_dwordx4 v254, s[20:23], s32 offen offset:0 sc1 lds
    buffer_load_dwordx4 v254, s[20:23], s32 offen offset:1024 sc1 lds
    buffer_load_dwordx4 v254, s[20:23], s32 offen offset:2048 sc1 lds
    buffer_load_dwordx4 v254, s[20:23], s32 offen offset:3072 sc1 lds
    s_waitcnt vmcnt(4)
    s_barrier
    s_add_u32 m0, s35, 16384
    s_add_u32 s32, s34, 212992
    buffer_load_dwordx4 v254, s[20:23], s32 offen offset:0 sc1 lds
    buffer_load_dwordx4 v254, s[20:23], s32 offen offset:1024 sc1 lds
    buffer_load_dwordx4 v254, s[20:23], s32 offen offset:2048 sc1 lds
    buffer_load_dwordx4 v254, s[20:23], s32 offen offset:3072 sc1 lds
    s_waitcnt vmcnt(4)
    s_barrier
    s_add_u32 m0, s35, 32768
    s_add_u32 s32, s34, 229376
    buffer_load_dwordx4 v254, s[20:23], s32 offen offset:0 sc1 lds
    buffer_load_dwordx4 v254, s[20:23], s32 offen offset:1024 sc1 lds
    buffer_load_dwordx4 v254, s[20:23], s32 offen offset:2048 sc1 lds
    buffer_load_dwordx4 v254, s[20:23], s32 offen offset:3072 sc1 lds
    s_waitcnt vmcnt(4)
    s_barrier
    s_add_u32 m0, s35, 49152
    s_add_u32 s32, s34, 245760
    buffer_load_dwordx4 v254, s[20:23], s32 offen offset:0 sc1 lds
    buffer_load_dwordx4 v254, s[20:23], s32 offen offset:1024 sc1 lds
    buffer_load_dwordx4 v254, s[20:23], s32 offen offset:2048 sc1 lds
    buffer_load_dwordx4 v254, s[20:23], s32 offen offset:3072 sc1 lds
    s_waitcnt vmcnt(4)
    s_barrier
    s_waitcnt vmcnt(0)
    s_barrier
    s_barrier
    s_barrier
    s_barrier
    s_setprio 3
    s_barrier
    s_lshl_b32 s32, s30, 4
    s_add_u32 s32, s32, s29
    s_lshl_b32 s32, s32, 7
    s_add_u32 s32, s32, 19202048
    s_min_u32 s33, s28, 1
    s_lshl_b32 s33, s33, 19
    s_add_u32 s32, s32, s33
    v_mov_b32 v9, s27
    v_mov_b32 v249, 0
    s_mov_b64 exec, 1
    buffer_store_dword v9, v249, s[20:23], s32 offen offset:0 sc1
    s_mov_b64 exec, -1
    s_sub_u32 s32, s2, s28
    s_cmp_lg_u32 s32, 255
    s_cbranch_scc1 L_k12_nadv
    v_lshlrev_b32 v13, 7, v253
    s_mov_b32 s32, 19005440
    s_mov_b32 exec_lo, 0xffffffff
    s_mov_b32 exec_hi, 0xffffffff
    s_mov_b32 s31, 0
L_k12_pc0:
    buffer_load_dword v15, v13, s[20:23], s32 offen sc1
    s_add_u32 s31, s31, 1
    s_waitcnt vmcnt(0)
    v_cmp_ne_u32 vcc, s27, v15
    s_cmp_gt_u32 s31, 131072
    s_cbranch_scc1 L_k12_pc0_out
    s_and_b64 exec, exec, vcc
    s_cbranch_scc0 L_k12_pc0_out
    s_sleep 4
    s_branch L_k12_pc0
L_k12_pc0_out:
    s_mov_b64 exec, -1
    s_mov_b32 s32, 19013632
    s_mov_b32 exec_lo, 0xffffffff
    s_mov_b32 exec_hi, 0xffffffff
    s_mov_b32 s31, 0
L_k12_pc1:
    buffer_load_dword v15, v13, s[20:23], s32 offen sc1
    s_add_u32 s31, s31, 1
    s_waitcnt vmcnt(0)
    v_cmp_ne_u32 vcc, s27, v15
    s_cmp_gt_u32 s31, 131072
    s_cbranch_scc1 L_k12_pc1_out
    s_and_b64 exec, exec, vcc
    s_cbranch_scc0 L_k12_pc1_out
    s_sleep 4
    s_branch L_k12_pc1
L_k12_pc1_out:
    s_mov_b64 exec, -1
    s_mov_b32 s32, 19021824
    s_mov_b32 exec_lo, 0xffffffff
    s_mov_b32 exec_hi, 0xffffffff
    s_mov_b32 s31, 0
L_k12_pc2:
    buffer_load_dword v15, v13, s[20:23], s32 offen sc1
    s_add_u32 s31, s31, 1
    s_waitcnt vmcnt(0)
    v_cmp_ne_u32 vcc, s27, v15
    s_cmp_gt_u32 s31, 131072
    s_cbranch_scc1 L_k12_pc2_out
    s_and_b64 exec, exec, vcc
    s_cbranch_scc0 L_k12_pc2_out
    s_sleep 4
    s_branch L_k12_pc2
L_k12_pc2_out:
    s_mov_b64 exec, -1
    s_mov_b32 s32, 19030016
    s_mov_b32 exec_lo, 0xffffffff
    s_mov_b32 exec_hi, 0xffffffff
    s_mov_b32 s31, 0
L_k12_pc3:
    buffer_load_dword v15, v13, s[20:23], s32 offen sc1
    s_add_u32 s31, s31, 1
    s_waitcnt vmcnt(0)
    v_cmp_ne_u32 vcc, s27, v15
    s_cmp_gt_u32 s31, 131072
    s_cbranch_scc1 L_k12_pc3_out
    s_and_b64 exec, exec, vcc
    s_cbranch_scc0 L_k12_pc3_out
    s_sleep 4
    s_branch L_k12_pc3
L_k12_pc3_out:
    s_mov_b64 exec, -1
    s_mov_b32 s32, 19136512
    s_mov_b64 exec, 1
    buffer_store_dword v9, v249, s[20:23], s32 offen offset:0 sc1
    s_mov_b64 exec, -1
L_k12_nadv:
    s_endpgm
L_k12_heavy:
    s_cmp_ge_u32 s26, 12
    s_cbranch_scc1 L_k12_compY
    s_lshr_b32 s29, s28, 1
    s_and_b32 s30, s28, 1
    s_lshl_b32 s34, s25, 1
    s_add_u32 s34, s34, s29
    s_lshl_b32 s34, s34, 1
    v_and_b32 v250, 31, v253
    v_lshrrev_b32 v251, 5, v253
    v_bfe_u32 v252, v253, 1, 3
    v_xor_b32 v252, v252, v251
    v_lshlrev_b32 v250, 7, v250
    s_lshl_b32 s32, s29, 13
    v_add_u32 v250, s32, v250
    v_xor_b32 v232, 0, v252
    v_lshl_add_u32 v232, v232, 4, v250
    v_add_u32 v236, 65536, v232
    v_xor_b32 v233, 2, v252
    v_lshl_add_u32 v233, v233, 4, v250
    v_add_u32 v237, 65536, v233
    v_xor_b32 v234, 4, v252
    v_lshl_add_u32 v234, v234, 4, v250
    v_add_u32 v238, 65536, v234
    v_xor_b32 v235, 6, v252
    v_lshl_add_u32 v235, v235, 4, v250
    v_add_u32 v239, 65536, v235
    v_bfe_u32 v250, v253, 2, 2
    v_lshl_add_u32 v250, v251, 3, v250
    v_bfe_u32 v252, v253, 4, 1
    v_lshlrev_b32 v252, 5, v252
    v_and_b32 v251, 3, v253
    v_lshl_add_u32 v252, v251, 3, v252
    v_lshl_add_u32 v252, v250, 7, v252
    v_bfe_u32 v251, v253, 3, 1
    v_xor_b32 v251, s30, v251
    v_lshl_add_u32 v240, v251, 6, v252
    v_add_u32 v240, 114688, v240
    s_mov_b32 s39, 0xbfb8aa3b
    s_lshl_b32 s31, s26, 1
    s_add_u32 s31, s31, s30
    s_mul_i32 s35, s34, 114688
    s_lshl_b32 s33, s31, 11
    s_add_u32 s35, s35, s33
    s_add_u32 s35, s35, 6291456
    s_and_b32 s33, s31, 15
    s_lshl_b32 s33, s33, 6
    s_add_u32 s33, s33, s34
    s_cmp_lt_u32 s31, 16
    s_cselect_b32 s37, 11, 12
    s_cselect_b32 s36, 0, 2097152
    s_cselect_b32 s38, 0x3e8b97f6, 1.0
    s_lshl_b32 s37, 1, s37
    s_mul_i32 s33, s33, s37
    s_add_u32 s36, s36, s33
    v_cmp_gt_u32 vcc, 32, v253
    v_mov_b32 v250, s38
    v_mov_b32 v251, 0
    v_cndmask_b32 v241, v251, v250, vcc
    s_waitcnt lgkmcnt(0)
    s_mov_b32 s20, s90
    s_mov_b32 s21, s91
    s_mov_b32 s22, 19922944
    s_mov_b32 s23, 0x20000
    s_mov_b32 s64, s84
    s_mov_b32 s65, s85
    s_mov_b32 s66, 1605632
    s_mov_b32 s67, 0x20000
    s_barrier
    ds_read_b128 v[160:163], v232 offset:0
    ds_read_b128 v[164:167], v232 offset:4096
    ds_read_b64_tr_b16 v[168:169], v240 offset:0
    ds_read_b64_tr_b16 v[170:171], v240 offset:512
    ds_read_b128 v[176:179], v233 offset:0
    ds_read_b128 v[180:183], v233 offset:4096
    ds_read_b64_tr_b16 v[184:185], v240 offset:2048
    ds_read_b64_tr_b16 v[186:187], v240 offset:2560
    s_waitcnt lgkmcnt(4)
    v_mfma_f32_32x32x16_bf16 v[128:143], v[168:171], v[160:163], 0
    ds_read_b128 v[192:195], v234 offset:0
    ds_read_b128 v[196:199], v234 offset:4096
    v_mfma_f32_32x32x16_bf16 v[144:159], v[168:171], v[164:167], 0
    ds_read_b64_tr_b16 v[200:201], v240 offset:4096
    ds_read_b64_tr_b16 v[202:203], v240 offset:4608
    s_waitcnt lgkmcnt(4)
    v_mfma_f32_32x32x16_bf16 v[128:143], v[184:187], v[176:179], v[128:143]
    ds_read_b128 v[160:163], v235 offset:0
    ds_read_b128 v[164:167], v235 offset:4096
    v_mfma_f32_32x32x16_bf16 v[144:159], v[184:187], v[180:183], v[144:159]
    ds_read_b64_tr_b16 v[168:169], v240 offset:6144
    ds_read_b64_tr_b16 v[170:171], v240 offset:6656
    s_waitcnt lgkmcnt(4)
    v_mfma_f32_32x32x16_bf16 v[128:143], v[200:203], v[192:195], v[128:143]
    ds_read_b128 v[176:179], v232 offset:16384
    ds_read_b128 v[180:183], v232 offset:20480
    v_mfma_f32_32x32x16_bf16 v[144:159], v[200:203], v[196:199], v[144:159]
    ds_read_b64_tr_b16 v[184:185], v240 offset:8192
    ds_read_b64_tr_b16 v[186:187], v240 offset:8704
    s_waitcnt lgkmcnt(4)
    v_mfma_f32_32x32x16_bf16 v[128:143], v[168:171], v[160:163], v[128:143]
    ds_read_b128 v[192:195], v233 offset:16384
    ds_read_b128 v[196:199], v233 offset:20480
    v_mfma_f32_32x32x16_bf16 v[144:159], v[168:171], v[164:167], v[144:159]
    ds_read_b64_tr_b16 v[200:201], v240 offset:10240
    ds_read_b64_tr_b16 v[202:203], v240 offset:10752
    s_waitcnt lgkmcnt(4)
    v_mfma_f32_32x32x16_bf16 v[128:143], v[184:187], v[176:179], v[128:143]
    ds_read_b128 v[160:163], v234 offset:16384
    ds_read_b128 v[164:167], v234 offset:20480
    s_mov_b32 s55, 0x20000
    s_mov_b32 s54, 1605632
    s_and_b32 s32, s28, 1
    s_cmp_eq_u32 s32, 0
    s_cselect_b32 s52, s80, s82
    s_cselect_b32 s53, s81, s83
    s_and_b32 s33, s25, 7
    s_lshl_b32 s33, s33, 1
    s_lshr_b32 s31, s28, 1
    s_add_u32 s33, s33, s31
    v_min_u32 v250, 27, v253
    s_mul_i32 s33, s33, 100352
    s_lshl_b32 s32, s26, 7
    v_mul_u32_u24 v252, 3584, v250
    s_add_u32 s33, s33, s32
    buffer_load_dword v243, v252, s[52:55], s33 offen offset:0
    v_mfma_f32_32x32x16_bf16 v[144:159], v[184:187], v[180:183], v[144:159]
    ds_read_b64_tr_b16 v[168:169], v240 offset:12288
    ds_read_b64_tr_b16 v[170:171], v240 offset:12800
    s_waitcnt lgkmcnt(4)
    v_mfma_f32_32x32x16_bf16 v[128:143], v[200:203], v[192:195], v[128:143]
    ds_read_b128 v[176:179], v235 offset:16384
    ds_read_b128 v[180:183], v235 offset:20480
    v_mfma_f32_32x32x16_bf16 v[144:159], v[200:203], v[196:199], v[144:159]
    ds_read_b64_tr_b16 v[184:185], v240 offset:14336
    ds_read_b64_tr_b16 v[186:187], v240 offset:14848
    s_waitcnt lgkmcnt(4)
    v_mfma_f32_32x32x16_bf16 v[128:143], v[168:171], v[160:163], v[128:143]
    v_mfma_f32_32x32x16_bf16 v[144:159], v[168:171], v[164:167], v[144:159]
    s_waitcnt lgkmcnt(0)
    s_barrier
    ds_read_b128 v[192:195], v232 offset:32768
    ds_read_b128 v[196:199], v232 offset:36864
    ds_read_b64_tr_b16 v[200:201], v240 offset:16384
    ds_read_b64_tr_b16 v[202:203], v240 offset:16896
    v_mfma_f32_32x32x16_bf16 v[128:143], v[184:187], v[176:179], v[128:143]
    ds_read_b128 v[160:163], v233 offset:32768
    ds_read_b128 v[164:167], v233 offset:36864
    v_mfma_f32_32x32x16_bf16 v[144:159], v[184:187], v[180:183], v[144:159]
    ds_read_b64_tr_b16 v[168:169], v240 offset:18432
    ds_read_b64_tr_b16 v[170:171], v240 offset:18944
    s_waitcnt lgkmcnt(4)
    v_mfma_f32_32x32x16_bf16 v[128:143], v[200:203], v[192:195], v[128:143]
    ds_read_b128 v[176:179], v234 offset:32768
    ds_read_b128 v[180:183], v234 offset:36864
    v_mfma_f32_32x32x16_bf16 v[144:159], v[200:203], v[196:199], v[144:159]
    ds_read_b64_tr_b16 v[184:185], v240 offset:20480
    ds_read_b64_tr_b16 v[186:187], v240 offset:20992
    s_waitcnt lgkmcnt(4)
    v_mfma_f32_32x32x16_bf16 v[128:143], v[168:171], v[160:163], v[128:143]
    ds_read_b128 v[192:195], v235 offset:32768
    ds_read_b128 v[196:199], v235 offset:36864
    v_mfma_f32_32x32x16_bf16 v[144:159], v[168:171], v[164:167], v[144:159]
    ds_read_b64_tr_b16 v[200:201], v240 offset:22528
    ds_read_b64_tr_b16 v[202:203], v240 offset:23040
    s_waitcnt lgkmcnt(4)
    v_mfma_f32_32x32x16_bf16 v[128:143], v[184:187], v[176:179], v[128:143]
    ds_read_b128 v[160:163], v232 offset:49152
    ds_read_b128 v[164:167], v232 offset:53248
    v_mfma_f32_32x32x16_bf16 v[144:159], v[184:187], v[180:183], v[144:159]
    ds_read_b64_tr_b16 v[168:169], v240 offset:24576
    ds_read_b64_tr_b16 v[170:171], v240 offset:25088
    s_waitcnt lgkmcnt(4)
    v_mfma_f32_32x32x16_bf16 v[128:143], v[200:203], v[192:195], v[128:143]
    ds_read_b128 v[176:179], v233 offset:49152
    ds_read_b128 v[180:183], v233 offset:53248
    v_mfma_f32_32x32x16_bf16 v[144:159], v[200:203], v[196:199], v[144:159]
    ds_read_b64_tr_b16 v[184:185], v240 offset:26624
    ds_read_b64_tr_b16 v[186:187], v240 offset:27136
    s_waitcnt lgkmcnt(4)
    v_mfma_f32_32x32x16_bf16 v[128:143], v[168:171], v[160:163], v[128:143]
    ds_read_b128 v[192:195], v234 offset:49152
    ds_read_b128 v[196:199], v234 offset:53248
    v_mfma_f32_32x32x16_bf16 v[144:159], v[168:171], v[164:167], v[144:159]
    ds_read_b64_tr_b16 v[200:201], v240 offset:28672
    ds_read_b64_tr_b16 v[202:203], v240 offset:29184
    s_waitcnt lgkmcnt(4)
    v_mfma_f32_32x32x16_bf16 v[128:143], v[184:187], v[176:179], v[128:143]
    ds_read_b128 v[160:163], v235 offset:49152
    ds_read_b128 v[164:167], v235 offset:53248
    v_mfma_f32_32x32x16_bf16 v[144:159], v[184:187], v[180:183], v[144:159]
    ds_read_b64_tr_b16 v[168:169], v240 offset:30720
    ds_read_b64_tr_b16 v[170:171], v240 offset:31232
    s_waitcnt lgkmcnt(4)
    v_mfma_f32_32x32x16_bf16 v[128:143], v[200:203], v[192:195], v[128:143]
    v_mfma_f32_32x32x16_bf16 v[144:159], v[200:203], v[196:199], v[144:159]
    s_waitcnt lgkmcnt(0)
    s_barrier
    ds_read_b128 v[176:179], v236 offset:0
    ds_read_b128 v[180:183], v236 offset:4096
    ds_read_b64_tr_b16 v[184:185], v240 offset:32768
    ds_read_b64_tr_b16 v[186:187], v240 offset:33280
    v_mfma_f32_32x32x16_bf16 v[128:143], v[168:171], v[160:163], v[128:143]
    ds_read_b128 v[192:195], v237 offset:0
    ds_read_b128 v[196:199], v237 offset:4096
    v_mfma_f32_32x32x16_bf16 v[144:159], v[168:171], v[164:167], v[144:159]
    ds_read_b64_tr_b16 v[200:201], v240 offset:34816
    ds_read_b64_tr_b16 v[202:203], v240 offset:35328
    s_waitcnt lgkmcnt(4)
    v_mfma_f32_32x32x16_bf16 v[128:143], v[184:187], v[176:179], v[128:143]
    ds_read_b128 v[160:163], v238 offset:0
    ds_read_b128 v[164:167], v238 offset:4096
    v_mfma_f32_32x32x16_bf16 v[144:159], v[184:187], v[180:183], v[144:159]
    ds_read_b64_tr_b16 v[168:169], v240 offset:36864
    ds_read_b64_tr_b16 v[170:171], v240 offset:37376
    s_waitcnt lgkmcnt(4)
    v_mfma_f32_32x32x16_bf16 v[128:143], v[200:203], v[192:195], v[128:143]
    ds_read_b128 v[176:179], v239 offset:0
    ds_read_b128 v[180:183], v239 offset:4096
    v_mfma_f32_32x32x16_bf16 v[144:159], v[200:203], v[196:199], v[144:159]
    ds_read_b64_tr_b16 v[184:185], v240 offset:38912
    ds_read_b64_tr_b16 v[186:187], v240 offset:39424
    s_waitcnt lgkmcnt(4)
    v_mfma_f32_32x32x16_bf16 v[128:143], v[168:171], v[160:163], v[128:143]
    ds_read_b128 v[192:195], v236 offset:16384
    ds_read_b128 v[196:199], v236 offset:20480
    v_mfma_f32_32x32x16_bf16 v[144:159], v[168:171], v[164:167], v[144:159]
    ds_read_b64_tr_b16 v[200:201], v240 offset:40960
    ds_read_b64_tr_b16 v[202:203], v240 offset:41472
    s_waitcnt lgkmcnt(4)
    v_mfma_f32_32x32x16_bf16 v[128:143], v[184:187], v[176:179], v[128:143]
    ds_read_b128 v[160:163], v237 offset:16384
    ds_read_b128 v[164:167], v237 offset:20480
    v_mfma_f32_32x32x16_bf16 v[144:159], v[184:187], v[180:183], v[144:159]
    ds_read_b64_tr_b16 v[168:169], v240 offset:43008
    ds_read_b64_tr_b16 v[170:171], v240 offset:43520
    s_waitcnt lgkmcnt(4)
    v_mfma_f32_32x32x16_bf16 v[128:143], v[200:203], v[192:195], v[128:143]
    ds_read_b128 v[176:179], v238 offset:16384
    ds_read_b128 v[180:183], v238 offset:20480
    v_mfma_f32_32x32x16_bf16 v[144:159], v[200:203], v[196:199], v[144:159]
    ds_read_b64_tr_b16 v[184:185], v240 offset:45056
    ds_read_b64_tr_b16 v[186:187], v240 offset:45568
    s_waitcnt lgkmcnt(4)
    v_mfma_f32_32x32x16_bf16 v[128:143], v[168:171], v[160:163], v[128:143]
    ds_read_b128 v[192:195], v239 offset:16384
    ds_read_b128 v[196:199], v239 offset:20480
    v_mfma_f32_32x32x16_bf16 v[144:159], v[168:171], v[164:167], v[144:159]
    ds_read_b64_tr_b16 v[200:201], v240 offset:47104
    ds_read_b64_tr_b16 v[202:203], v240 offset:47616
    s_waitcnt lgkmcnt(4)
    v_mfma_f32_32x32x16_bf16 v[128:143], v[184:187], v[176:179], v[128:143]
    v_mfma_f32_32x32x16_bf16 v[144:159], v[184:187], v[180:183], v[144:159]
    s_waitcnt lgkmcnt(0)
    s_barrier
    ds_read_b128 v[160:163], v236 offset:32768
    ds_read_b128 v[164:167], v236 offset:36864
    ds_read_b64_tr_b16 v[168:169], v240 offset:0
    ds_read_b64_tr_b16 v[170:171], v240 offset:512
    v_mfma_f32_32x32x16_bf16 v[128:143], v[200:203], v[192:195], v[128:143]
    ds_read_b128 v[176:179], v237 offset:32768
    ds_read_b128 v[180:183], v237 offset:36864
    v_mfma_f32_32x32x16_bf16 v[144:159], v[200:203], v[196:199], v[144:159]
    ds_read_b64_tr_b16 v[184:185], v240 offset:2048
    ds_read_b64_tr_b16 v[186:187], v240 offset:2560
    s_waitcnt lgkmcnt(4)
    v_mfma_f32_32x32x16_bf16 v[128:143], v[168:171], v[160:163], v[128:143]
    ds_read_b128 v[192:195], v238 offset:32768
    ds_read_b128 v[196:199], v238 offset:36864
    s_mov_b32 s55, 0x20000
    s_mov_b32 s54, 1605632
    s_and_b32 s32, s28, 1
    s_cmp_eq_u32 s32, 0
    s_cselect_b32 s52, s80, s82
    s_cselect_b32 s53, s81, s83
    s_and_b32 s33, s25, 7
    s_lshl_b32 s33, s33, 1
    s_lshr_b32 s31, s28, 1
    s_add_u32 s33, s33, s31
    v_min_u32 v250, 27, v253
    s_mul_i32 s33, s33, 100352
    s_lshl_b32 s32, s26, 7
    s_add_u32 s32, s32, 1536
    v_mul_u32_u24 v252, 3584, v250
    s_add_u32 s33, s33, s32
    buffer_load_dword v244, v252, s[52:55], s33 offen offset:0
    v_mfma_f32_32x32x16_bf16 v[144:159], v[168:171], v[164:167], v[144:159]
    ds_read_b64_tr_b16 v[200:201], v240 offset:4096
    ds_read_b64_tr_b16 v[202:203], v240 offset:4608
    s_waitcnt lgkmcnt(4)
    v_mfma_f32_32x32x16_bf16 v[128:143], v[184:187], v[176:179], v[128:143]
    ds_read_b128 v[160:163], v239 offset:32768
    ds_read_b128 v[164:167], v239 offset:36864
    v_mfma_f32_32x32x16_bf16 v[144:159], v[184:187], v[180:183], v[144:159]
    ds_read_b64_tr_b16 v[168:169], v240 offset:6144
    ds_read_b64_tr_b16 v[170:171], v240 offset:6656
    s_waitcnt lgkmcnt(4)
    v_mfma_f32_32x32x16_bf16 v[128:143], v[200:203], v[192:195], v[128:143]
    ds_read_b128 v[176:179], v232 offset:0
    ds_read_b128 v[180:183], v232 offset:4096
    v_mfma_f32_32x32x16_bf16 v[144:159], v[200:203], v[196:199], v[144:159]
    s_waitcnt lgkmcnt(2)
    s_barrier
    ds_read_b64_tr_b16 v[184:185], v240 offset:16384
    ds_read_b64_tr_b16 v[186:187], v240 offset:16896
    ds_read_b64_tr_b16 v[188:189], v240 offset:24576
    ds_read_b64_tr_b16 v[190:191], v240 offset:25088
    v_mfma_f32_32x32x16_bf16 v[128:143], v[168:171], v[160:163], v[128:143]
    ds_read_b128 v[192:195], v233 offset:0
    ds_read_b128 v[196:199], v233 offset:4096
    ds_read_b64_tr_b16 v[200:201], v240 offset:18432
    v_mfma_f32_32x32x16_bf16 v[144:159], v[168:171], v[164:167], v[144:159]
    ds_read_b64_tr_b16 v[202:203], v240 offset:18944
    ds_read_b64_tr_b16 v[204:205], v240 offset:26624
    ds_read_b64_tr_b16 v[206:207], v240 offset:27136
    s_waitcnt lgkmcnt(6)
    v_mfma_f32_32x32x16_bf16 v[0:15], v[184:187], v[176:179], 0
    ds_read_b128 v[160:163], v234 offset:0
    ds_read_b128 v[164:167], v234 offset:4096
    v_mfma_f32_32x32x16_bf16 v[16:31], v[184:187], v[180:183], 0
    ds_read_b64_tr_b16 v[168:169], v240 offset:20480
    ds_read_b64_tr_b16 v[170:171], v240 offset:20992
    v_cvt_pk_bf16_f32 v208, v140, v140
    v_mul_f32 v128, s38, v128
    v_mul_f32 v129, s38, v129
    v_mfma_f32_32x32x16_bf16 v[32:47], v[188:191], v[176:179], 0
    ds_read_b64_tr_b16 v[172:173], v240 offset:28672
    v_mul_f32 v130, s38, v130
    v_mul_f32 v131, s38, v131
    v_mul_f32 v132, s38, v132
    v_mfma_f32_32x32x16_bf16 v[48:63], v[188:191], v[180:183], 0
    ds_read_b64_tr_b16 v[174:175], v240 offset:29184
    v_mul_f32 v133, s38, v133
    v_mul_f32 v134, s38, v134
    v_mul_f32 v135, s38, v135
    s_waitcnt lgkmcnt(6)
    v_mfma_f32_32x32x16_bf16 v[0:15], v[200:203], v[192:195], v[0:15]
    ds_read_b128 v[176:179], v235 offset:0
    ds_read_b128 v[180:183], v235 offset:4096
    v_mul_f32 v136, s38, v136
    v_mul_f32 v137, s38, v137
    v_mul_f32 v138, s38, v138
    v_mfma_f32_32x32x16_bf16 v[16:31], v[200:203], v[196:199], v[16:31]
    ds_read_b64_tr_b16 v[184:185], v240 offset:22528
    ds_read_b64_tr_b16 v[186:187], v240 offset:23040
    v_mul_f32 v139, s38, v139
    v_mul_f32 v140, v241, v140
    v_mul_f32 v141, v241, v141
    v_mfma_f32_32x32x16_bf16 v[32:47], v[204:207], v[192:195], v[32:47]
    ds_read_b64_tr_b16 v[188:189], v240 offset:30720
    v_mul_f32 v142, v241, v142
    v_mul_f32 v143, v241, v143
    v_cvt_pk_bf16_f32 v128, v128, v129
    v_mfma_f32_32x32x16_bf16 v[48:63], v[204:207], v[196:199], v[48:63]
    ds_read_b64_tr_b16 v[190:191], v240 offset:31232
    v_cvt_pk_bf16_f32 v129, v130, v131
    v_cvt_pk_bf16_f32 v130, v132, v133
    v_cvt_pk_bf16_f32 v131, v134, v135
    s_waitcnt lgkmcnt(6)
    v_mfma_f32_32x32x16_bf16 v[0:15], v[168:171], v[160:163], v[0:15]
    ds_read_b128 v[192:195], v232 offset:16384
    ds_read_b128 v[196:199], v232 offset:20480
    v_cvt_pk_bf16_f32 v132, v136, v137
    v_cvt_pk_bf16_f32 v133, v138, v139
    v_cvt_pk_bf16_f32 v134, v140, v141
    v_mfma_f32_32x32x16_bf16 v[16:31], v[168:171], v[164:167], v[16:31]
    v_cvt_pk_bf16_f32 v135, v142, v143
    v_cvt_pk_bf16_f32 v209, v156, v156
    v_mul_f32 v144, s38, v144
    v_mfma_f32_32x32x16_bf16 v[32:47], v[172:175], v[160:163], v[32:47]
    s_waitcnt lgkmcnt(2)
    s_barrier
    ds_read_b64_tr_b16 v[200:201], v240 offset:32768
    ds_read_b64_tr_b16 v[202:203], v240 offset:33280
    v_mul_f32 v145, s38, v145
    v_mul_f32 v146, s38, v146
    v_mul_f32 v147, s38, v147
    v_mfma_f32_32x32x16_bf16 v[48:63], v[172:175], v[164:167], v[48:63]
    ds_read_b64_tr_b16 v[204:205], v240 offset:40960
    ds_read_b64_tr_b16 v[206:207], v240 offset:41472
    v_mul_f32 v148, s38, v148
    v_mul_f32 v149, s38, v149
    v_mul_f32 v150, s38, v150
    v_mfma_f32_32x32x16_bf16 v[0:15], v[184:187], v[176:179], v[0:15]
    ds_read_b128 v[160:163], v233 offset:16384
    ds_read_b128 v[164:167], v233 offset:20480
    v_mul_f32 v151, s38, v151
    v_mul_f32 v152, s38, v152
    v_mul_f32 v153, s38, v153
    v_mfma_f32_32x32x16_bf16 v[16:31], v[184:187], v[180:183], v[16:31]
    ds_read_b64_tr_b16 v[168:169], v240 offset:34816
    ds_read_b64_tr_b16 v[170:171], v240 offset:35328
    v_mul_f32 v154, s38, v154
    v_mul_f32 v155, s38, v155
    v_mul_f32 v156, v241, v156
    v_mfma_f32_32x32x16_bf16 v[32:47], v[188:191], v[176:179], v[32:47]
    ds_read_b64_tr_b16 v[172:173], v240 offset:43008
    v_mul_f32 v157, v241, v157
    v_mul_f32 v158, v241, v158
    v_mul_f32 v159, v241, v159
    v_mfma_f32_32x32x16_bf16 v[48:63], v[188:191], v[180:183], v[48:63]
    ds_read_b64_tr_b16 v[174:175], v240 offset:43520
    v_cvt_pk_bf16_f32 v144, v144, v145
    v_cvt_pk_bf16_f32 v145, v146, v147
    v_cvt_pk_bf16_f32 v146, v148, v149
    s_waitcnt lgkmcnt(6)
    v_mfma_f32_32x32x16_bf16 v[0:15], v[200:203], v[192:195], v[0:15]
    ds_read_b128 v[176:179], v234 offset:16384
    ds_read_b128 v[180:183], v234 offset:20480
    v_cvt_pk_bf16_f32 v147, v150, v151
    v_cvt_pk_bf16_f32 v148, v152, v153
    v_cvt_pk_bf16_f32 v149, v154, v155
    v_mfma_f32_32x32x16_bf16 v[16:31], v[200:203], v[196:199], v[16:31]
    ds_read_b64_tr_b16 v[184:185], v240 offset:36864
    ds_read_b64_tr_b16 v[186:187], v240 offset:37376
    v_cvt_pk_bf16_f32 v150, v156, v157
    v_cvt_pk_bf16_f32 v151, v158, v159
    v_and_b32 v208, 0xffff0000, v208
    v_mfma_f32_32x32x16_bf16 v[32:47], v[204:207], v[192:195], v[32:47]
    ds_read_b64_tr_b16 v[188:189], v240 offset:45056
    buffer_store_dwordx4 v[128:131], v254, s[20:23], s36 offen offset:0 sc1
    v_mul_f32 v208, s39, v208
    v_mfma_f32_32x32x16_bf16 v[48:63], v[204:207], v[196:199], v[48:63]
    ds_read_b64_tr_b16 v[190:191], v240 offset:45568
    buffer_store_dwordx4 v[132:135], v254, s[20:23], s36 offen offset:1024 sc1
    s_waitcnt lgkmcnt(6)
    v_mfma_f32_32x32x16_bf16 v[0:15], v[168:171], v[160:163], v[0:15]
    ds_read_b128 v[192:195], v235 offset:16384
    ds_read_b128 v[196:199], v235 offset:20480
    s_add_u32 s36, s36, s37
    buffer_store_dwordx4 v[144:147], v254, s[20:23], s36 offen offset:0 sc1
    v_mfma_f32_32x32x16_bf16 v[16:31], v[168:171], v[164:167], v[16:31]
    ds_read_b64_tr_b16 v[200:201], v240 offset:38912
    ds_read_b64_tr_b16 v[202:203], v240 offset:39424
    buffer_store_dwordx4 v[148:151], v254, s[20:23], s36 offen offset:1024 sc1
    v_mfma_f32_32x32x16_bf16 v[32:47], v[172:175], v[160:163], v[32:47]
    ds_read_b64_tr_b16 v[204:205], v240 offset:47104
    v_exp_f32 v208, v208
    v_mov_b32 v210, 0
    v_mfma_f32_32x32x16_bf16 v[48:63], v[172:175], v[164:167], v[48:63]
    ds_read_b64_tr_b16 v[206:207], v240 offset:47616
    v_add_f32 v208, 1.0, v208
    v_rcp_f32 v208, v208
    s_waitcnt lgkmcnt(6)
    v_mfma_f32_32x32x16_bf16 v[0:15], v[184:187], v[176:179], v[0:15]
    ds_read_b128 v[160:163], v232 offset:32768
    ds_read_b128 v[164:167], v232 offset:36864
    v_mov_b32 v210, 0
    v_cvt_pk_bf16_f32 v208, v208, v208
    v_and_b32 v210, 0xffff0000, v208
    v_mfma_f32_32x32x16_bf16 v[16:31], v[184:187], v[180:183], v[16:31]
    v_sub_f32 v211, 1.0, v210
    v_cvt_pk_bf16_f32 v211, v211, v211
    v_and_b32 v211, 0xffff0000, v211
    v_mfma_f32_32x32x16_bf16 v[32:47], v[188:191], v[176:179], v[32:47]
    s_waitcnt lgkmcnt(2)
    s_barrier
    ds_read_b64_tr_b16 v[168:169], v240 offset:0
    ds_read_b64_tr_b16 v[170:171], v240 offset:512
    v_and_b32 v209, 0xffff0000, v209
    v_mul_f32 v209, s39, v209
    v_mfma_f32_32x32x16_bf16 v[48:63], v[188:191], v[180:183], v[48:63]
    ds_read_b64_tr_b16 v[172:173], v240 offset:8192
    ds_read_b64_tr_b16 v[174:175], v240 offset:8704
    v_exp_f32 v209, v209
    v_mov_b32 v212, 0
    v_mfma_f32_32x32x16_bf16 v[0:15], v[200:203], v[192:195], v[0:15]
    ds_read_b128 v[176:179], v233 offset:32768
    ds_read_b128 v[180:183], v233 offset:36864
    v_add_f32 v209, 1.0, v209
    v_rcp_f32 v209, v209
    v_mfma_f32_32x32x16_bf16 v[16:31], v[200:203], v[196:199], v[16:31]
    ds_read_b64_tr_b16 v[184:185], v240 offset:2048
    ds_read_b64_tr_b16 v[186:187], v240 offset:2560
    v_mov_b32 v212, 0
    v_cvt_pk_bf16_f32 v209, v209, v209
    v_and_b32 v212, 0xffff0000, v209
    v_mfma_f32_32x32x16_bf16 v[32:47], v[204:207], v[192:195], v[32:47]
    ds_read_b64_tr_b16 v[188:189], v240 offset:10240
    v_sub_f32 v213, 1.0, v212
    v_cvt_pk_bf16_f32 v213, v213, v213
    v_and_b32 v213, 0xffff0000, v213
    v_mfma_f32_32x32x16_bf16 v[48:63], v[204:207], v[196:199], v[48:63]
    ds_read_b64_tr_b16 v[190:191], v240 offset:10752
    s_waitcnt lgkmcnt(6)
    v_mfma_f32_32x32x16_bf16 v[0:15], v[168:171], v[160:163], v[0:15]
    ds_read_b128 v[192:195], v234 offset:32768
    ds_read_b128 v[196:199], v234 offset:36864
    v_mfma_f32_32x32x16_bf16 v[16:31], v[168:171], v[164:167], v[16:31]
    ds_read_b64_tr_b16 v[200:201], v240 offset:4096
    ds_read_b64_tr_b16 v[202:203], v240 offset:4608
    v_mfma_f32_32x32x16_bf16 v[32:47], v[172:175], v[160:163], v[32:47]
    ds_read_b64_tr_b16 v[204:205], v240 offset:12288
    v_lshlrev_b32 v250, 3, v253
    s_lshl_b32 s33, s34, 8
    s_add_u32 s33, s33, 18874112
    s_add_u32 s32, s30, s26
    s_min_u32 s32, s32, 1
    s_lshl_b32 s32, s32, 15
    s_add_u32 s33, s33, s32
    s_mov_b32 exec_lo, 0
    buffer_store_dwordx2 v[210:211], v250, s[20:23], s33 offen offset:0 sc1
    buffer_store_dwordx2 v[212:213], v250, s[20:23], s33 offen offset:256 sc1
    s_mov_b32 exec_lo, -1
    v_mfma_f32_32x32x16_bf16 v[48:63], v[172:175], v[164:167], v[48:63]
    ds_read_b64_tr_b16 v[206:207], v240 offset:12800
    s_waitcnt lgkmcnt(6)
    v_mfma_f32_32x32x16_bf16 v[0:15], v[184:187], v[176:179], v[0:15]
    ds_read_b128 v[160:163], v235 offset:32768
    ds_read_b128 v[164:167], v235 offset:36864
    v_mfma_f32_32x32x16_bf16 v[16:31], v[184:187], v[180:183], v[16:31]
    ds_read_b64_tr_b16 v[168:169], v240 offset:6144
    ds_read_b64_tr_b16 v[170:171], v240 offset:6656
    v_mfma_f32_32x32x16_bf16 v[32:47], v[188:191], v[176:179], v[32:47]
    ds_read_b64_tr_b16 v[172:173], v240 offset:14336
    v_mfma_f32_32x32x16_bf16 v[48:63], v[188:191], v[180:183], v[48:63]
    ds_read_b64_tr_b16 v[174:175], v240 offset:14848
    s_waitcnt lgkmcnt(6)
    v_mfma_f32_32x32x16_bf16 v[0:15], v[200:203], v[192:195], v[0:15]
    ds_read_b128 v[176:179], v232 offset:49152
    ds_read_b128 v[180:183], v232 offset:53248
    v_mfma_f32_32x32x16_bf16 v[16:31], v[200:203], v[196:199], v[16:31]
    v_mfma_f32_32x32x16_bf16 v[32:47], v[204:207], v[192:195], v[32:47]
    s_waitcnt lgkmcnt(2)
    s_barrier
    ds_read_b64_tr_b16 v[184:185], v240 offset:16384
    ds_read_b64_tr_b16 v[186:187], v240 offset:16896
    v_mfma_f32_32x32x16_bf16 v[48:63], v[204:207], v[196:199], v[48:63]
    ds_read_b64_tr_b16 v[188:189], v240 offset:24576
    ds_read_b64_tr_b16 v[190:191], v240 offset:25088
    v_mfma_f32_32x32x16_bf16 v[0:15], v[168:171], v[160:163], v[0:15]
    ds_read_b128 v[192:195], v233 offset:49152
    ds_read_b128 v[196:199], v233 offset:53248
    v_mfma_f32_32x32x16_bf16 v[16:31], v[168:171], v[164:167], v[16:31]
    ds_read_b64_tr_b16 v[200:201], v240 offset:18432
    ds_read_b64_tr_b16 v[202:203], v240 offset:18944
    v_mfma_f32_32x32x16_bf16 v[32:47], v[172:175], v[160:163], v[32:47]
    ds_read_b64_tr_b16 v[204:205], v240 offset:26624
    v_mfma_f32_32x32x16_bf16 v[48:63], v[172:175], v[164:167], v[48:63]
    ds_read_b64_tr_b16 v[206:207], v240 offset:27136
    s_waitcnt lgkmcnt(6)
    v_mfma_f32_32x32x16_bf16 v[0:15], v[184:187], v[176:179], v[0:15]
    ds_read_b128 v[160:163], v234 offset:49152
    ds_read_b128 v[164:167], v234 offset:53248
    v_mfma_f32_32x32x16_bf16 v[16:31], v[184:187], v[180:183], v[16:31]
    ds_read_b64_tr_b16 v[168:169], v240 offset:20480
    ds_read_b64_tr_b16 v[170:171], v240 offset:20992
    v_mfma_f32_32x32x16_bf16 v[32:47], v[188:191], v[176:179], v[32:47]
    ds_read_b64_tr_b16 v[172:173], v240 offset:28672
    v_mfma_f32_32x32x16_bf16 v[48:63], v[188:191], v[180:183], v[48:63]
    ds_read_b64_tr_b16 v[174:175], v240 offset:29184
    s_waitcnt lgkmcnt(6)
    v_mfma_f32_32x32x16_bf16 v[0:15], v[200:203], v[192:195], v[0:15]
    ds_read_b128 v[176:179], v235 offset:49152
    ds_read_b128 v[180:183], v235 offset:53248
    v_mfma_f32_32x32x16_bf16 v[16:31], v[200:203], v[196:199], v[16:31]
    ds_read_b64_tr_b16 v[184:185], v240 offset:22528
    ds_read_b64_tr_b16 v[186:187], v240 offset:23040
    v_mfma_f32_32x32x16_bf16 v[32:47], v[204:207], v[192:195], v[32:47]
    ds_read_b64_tr_b16 v[188:189], v240 offset:30720
    v_mfma_f32_32x32x16_bf16 v[48:63], v[204:207], v[196:199], v[48:63]
    ds_read_b64_tr_b16 v[190:191], v240 offset:31232
    s_waitcnt lgkmcnt(6)
    v_mfma_f32_32x32x16_bf16 v[0:15], v[168:171], v[160:163], v[0:15]
    ds_read_b128 v[192:195], v236 offset:0
    ds_read_b128 v[196:199], v236 offset:4096
    v_mfma_f32_32x32x16_bf16 v[16:31], v[168:171], v[164:167], v[16:31]
    v_mfma_f32_32x32x16_bf16 v[32:47], v[172:175], v[160:163], v[32:47]
    s_waitcnt lgkmcnt(2)
    s_barrier
    ds_read_b64_tr_b16 v[200:201], v240 offset:32768
    ds_read_b64_tr_b16 v[202:203], v240 offset:33280
    v_mfma_f32_32x32x16_bf16 v[48:63], v[172:175], v[164:167], v[48:63]
    ds_read_b64_tr_b16 v[204:205], v240 offset:40960
    ds_read_b64_tr_b16 v[206:207], v240 offset:41472
    v_mfma_f32_32x32x16_bf16 v[0:15], v[184:187], v[176:179], v[0:15]
    ds_read_b128 v[160:163], v237 offset:0
    ds_read_b128 v[164:167], v237 offset:4096
    v_mfma_f32_32x32x16_bf16 v[16:31], v[184:187], v[180:183], v[16:31]
    ds_read_b64_tr_b16 v[168:169], v240 offset:34816
    ds_read_b64_tr_b16 v[170:171], v240 offset:35328
    v_mfma_f32_32x32x16_bf16 v[32:47], v[188:191], v[176:179], v[32:47]
    ds_read_b64_tr_b16 v[172:173], v240 offset:43008
    v_mfma_f32_32x32x16_bf16 v[48:63], v[188:191], v[180:183], v[48:63]
    ds_read_b64_tr_b16 v[174:175], v240 offset:43520
    s_waitcnt lgkmcnt(6)
    v_mfma_f32_32x32x16_bf16 v[0:15], v[200:203], v[192:195], v[0:15]
    ds_read_b128 v[176:179], v238 offset:0
    ds_read_b128 v[180:183], v238 offset:4096
    v_mfma_f32_32x32x16_bf16 v[16:31], v[200:203], v[196:199], v[16:31]
    ds_read_b64_tr_b16 v[184:185], v240 offset:36864
    ds_read_b64_tr_b16 v[186:187], v240 offset:37376
    v_mfma_f32_32x32x16_bf16 v[32:47], v[204:207], v[192:195], v[32:47]
    ds_read_b64_tr_b16 v[188:189], v240 offset:45056
    s_mov_b32 s55, 0x20000
    s_mov_b32 s54, 1605632
    s_mov_b32 s52, s84
    s_mov_b32 s53, s85
    s_mul_i32 s32, s2, 6272
    s_mul_i32 s33, s28, 1664
    s_add_u32 s33, s32, s33
    v_min_u32 v250, 12, v253
    v_lshlrev_b32 v252, 7, v250
    buffer_load_dword v245, v252, s[52:55], s33 offen offset:0
    v_mfma_f32_32x32x16_bf16 v[48:63], v[204:207], v[196:199], v[48:63]
    ds_read_b64_tr_b16 v[190:191], v240 offset:45568
    s_waitcnt lgkmcnt(6)
    v_mfma_f32_32x32x16_bf16 v[0:15], v[168:171], v[160:163], v[0:15]
    ds_read_b128 v[192:195], v239 offset:0
    ds_read_b128 v[196:199], v239 offset:4096
    v_mfma_f32_32x32x16_bf16 v[16:31], v[168:171], v[164:167], v[16:31]
    ds_read_b64_tr_b16 v[200:201], v240 offset:38912
    ds_read_b64_tr_b16 v[202:203], v240 offset:39424
    v_mfma_f32_32x32x16_bf16 v[32:47], v[172:175], v[160:163], v[32:47]
    ds_read_b64_tr_b16 v[204:205], v240 offset:47104
    v_mfma_f32_32x32x16_bf16 v[48:63], v[172:175], v[164:167], v[48:63]
    ds_read_b64_tr_b16 v[206:207], v240 offset:47616
    s_waitcnt lgkmcnt(6)
    v_mfma_f32_32x32x16_bf16 v[0:15], v[184:187], v[176:179], v[0:15]
    ds_read_b128 v[160:163], v236 offset:16384
    ds_read_b128 v[164:167], v236 offset:20480
    v_mfma_f32_32x32x16_bf16 v[16:31], v[184:187], v[180:183], v[16:31]
    v_mfma_f32_32x32x16_bf16 v[32:47], v[188:191], v[176:179], v[32:47]
    s_waitcnt lgkmcnt(2)
    s_waitcnt vmcnt(1)
    s_barrier
    ds_read_b64_tr_b16 v[168:169], v240 offset:0
    ds_read_b64_tr_b16 v[170:171], v240 offset:512
    v_mfma_f32_32x32x16_bf16 v[48:63], v[188:191], v[180:183], v[48:63]
    ds_read_b64_tr_b16 v[172:173], v240 offset:8192
    ds_read_b64_tr_b16 v[174:175], v240 offset:8704
    v_mfma_f32_32x32x16_bf16 v[0:15], v[200:203], v[192:195], v[0:15]
    ds_read_b128 v[176:179], v237 offset:16384
    ds_read_b128 v[180:183], v237 offset:20480
    v_mfma_f32_32x32x16_bf16 v[16:31], v[200:203], v[196:199], v[16:31]
    ds_read_b64_tr_b16 v[184:185], v240 offset:2048
    ds_read_b64_tr_b16 v[186:187], v240 offset:2560
    v_mfma_f32_32x32x16_bf16 v[32:47], v[204:207], v[192:195], v[32:47]
    ds_read_b64_tr_b16 v[188:189], v240 offset:10240
    v_mfma_f32_32x32x16_bf16 v[48:63], v[204:207], v[196:199], v[48:63]
    ds_read_b64_tr_b16 v[190:191], v240 offset:10752
    s_waitcnt lgkmcnt(6)
    v_mfma_f32_32x32x16_bf16 v[0:15], v[168:171], v[160:163], v[0:15]
    ds_read_b128 v[192:195], v238 offset:16384
    ds_read_b128 v[196:199], v238 offset:20480
    v_mfma_f32_32x32x16_bf16 v[16:31], v[168:171], v[164:167], v[16:31]
    ds_read_b64_tr_b16 v[200:201], v240 offset:4096
    ds_read_b64_tr_b16 v[202:203], v240 offset:4608
    v_mfma_f32_32x32x16_bf16 v[32:47], v[172:175], v[160:163], v[32:47]
    ds_read_b64_tr_b16 v[204:205], v240 offset:12288
    v_mfma_f32_32x32x16_bf16 v[48:63], v[172:175], v[164:167], v[48:63]
    ds_read_b64_tr_b16 v[206:207], v240 offset:12800
    s_waitcnt lgkmcnt(6)
    v_mfma_f32_32x32x16_bf16 v[0:15], v[184:187], v[176:179], v[0:15]
    ds_read_b128 v[160:163], v239 offset:16384
    ds_read_b128 v[164:167], v239 offset:20480
    v_mfma_f32_32x32x16_bf16 v[16:31], v[184:187], v[180:183], v[16:31]
    ds_read_b64_tr_b16 v[168:169], v240 offset:6144
    ds_read_b64_tr_b16 v[170:171], v240 offset:6656
    v_mfma_f32_32x32x16_bf16 v[32:47], v[188:191], v[176:179], v[32:47]
    ds_read_b64_tr_b16 v[172:173], v240 offset:14336
    v_mfma_f32_32x32x16_bf16 v[48:63], v[188:191], v[180:183], v[48:63]
    ds_read_b64_tr_b16 v[174:175], v240 offset:14848
    s_waitcnt lgkmcnt(6)
    v_mfma_f32_32x32x16_bf16 v[0:15], v[200:203], v[192:195], v[0:15]
    ds_read_b128 v[176:179], v236 offset:32768
    ds_read_b128 v[180:183], v236 offset:36864
    v_mfma_f32_32x32x16_bf16 v[16:31], v[200:203], v[196:199], v[16:31]
    v_mfma_f32_32x32x16_bf16 v[32:47], v[204:207], v[192:195], v[32:47]
    s_waitcnt lgkmcnt(2)
    s_barrier
    ds_read_b64_tr_b16 v[184:185], v240 offset:16384
    ds_read_b64_tr_b16 v[186:187], v240 offset:16896
    v_mfma_f32_32x32x16_bf16 v[48:63], v[204:207], v[196:199], v[48:63]
    ds_read_b64_tr_b16 v[188:189], v240 offset:24576
    ds_read_b64_tr_b16 v[190:191], v240 offset:25088
    v_mfma_f32_32x32x16_bf16 v[0:15], v[168:171], v[160:163], v[0:15]
    ds_read_b128 v[192:195], v237 offset:32768
    ds_read_b128 v[196:199], v237 offset:36864
    v_mfma_f32_32x32x16_bf16 v[16:31], v[168:171], v[164:167], v[16:31]
    ds_read_b64_tr_b16 v[200:201], v240 offset:18432
    ds_read_b64_tr_b16 v[202:203], v240 offset:18944
    v_mfma_f32_32x32x16_bf16 v[32:47], v[172:175], v[160:163], v[32:47]
    ds_read_b64_tr_b16 v[204:205], v240 offset:26624
    v_mfma_f32_32x32x16_bf16 v[48:63], v[172:175], v[164:167], v[48:63]
    ds_read_b64_tr_b16 v[206:207], v240 offset:27136
    s_waitcnt lgkmcnt(6)
    v_mfma_f32_32x32x16_bf16 v[0:15], v[184:187], v[176:179], v[0:15]
    ds_read_b128 v[160:163], v238 offset:32768
    ds_read_b128 v[164:167], v238 offset:36864
    v_mfma_f32_32x32x16_bf16 v[16:31], v[184:187], v[180:183], v[16:31]
    ds_read_b64_tr_b16 v[168:169], v240 offset:20480
    ds_read_b64_tr_b16 v[170:171], v240 offset:20992
    v_mfma_f32_32x32x16_bf16 v[32:47], v[188:191], v[176:179], v[32:47]
    ds_read_b64_tr_b16 v[172:173], v240 offset:28672
    v_mfma_f32_32x32x16_bf16 v[48:63], v[188:191], v[180:183], v[48:63]
    ds_read_b64_tr_b16 v[174:175], v240 offset:29184
    s_waitcnt lgkmcnt(6)
    v_mfma_f32_32x32x16_bf16 v[0:15], v[200:203], v[192:195], v[0:15]
    ds_read_b128 v[176:179], v239 offset:32768
    ds_read_b128 v[180:183], v239 offset:36864
    v_mfma_f32_32x32x16_bf16 v[16:31], v[200:203], v[196:199], v[16:31]
    ds_read_b64_tr_b16 v[184:185], v240 offset:22528
    ds_read_b64_tr_b16 v[186:187], v240 offset:23040
    v_mfma_f32_32x32x16_bf16 v[32:47], v[204:207], v[192:195], v[32:47]
    ds_read_b64_tr_b16 v[188:189], v240 offset:30720
    v_mfma_f32_32x32x16_bf16 v[48:63], v[204:207], v[196:199], v[48:63]
    ds_read_b64_tr_b16 v[190:191], v240 offset:31232
    s_waitcnt lgkmcnt(6)
    v_mfma_f32_32x32x16_bf16 v[0:15], v[168:171], v[160:163], v[0:15]
    ds_read_b128 v[192:195], v232 offset:0
    ds_read_b128 v[196:199], v232 offset:4096
    v_mfma_f32_32x32x16_bf16 v[16:31], v[168:171], v[164:167], v[16:31]
    v_mfma_f32_32x32x16_bf16 v[32:47], v[172:175], v[160:163], v[32:47]
    s_waitcnt lgkmcnt(2)
    s_barrier
    ds_read_b64_tr_b16 v[200:201], v240 offset:32768
    ds_read_b64_tr_b16 v[202:203], v240 offset:33280
    v_mfma_f32_32x32x16_bf16 v[48:63], v[172:175], v[164:167], v[48:63]
    ds_read_b64_tr_b16 v[204:205], v240 offset:40960
    ds_read_b64_tr_b16 v[206:207], v240 offset:41472
    v_mfma_f32_32x32x16_bf16 v[0:15], v[184:187], v[176:179], v[0:15]
    ds_read_b128 v[160:163], v233 offset:0
    ds_read_b128 v[164:167], v233 offset:4096
    v_mfma_f32_32x32x16_bf16 v[16:31], v[184:187], v[180:183], v[16:31]
    ds_read_b64_tr_b16 v[168:169], v240 offset:34816
    ds_read_b64_tr_b16 v[170:171], v240 offset:35328
    v_mfma_f32_32x32x16_bf16 v[32:47], v[188:191], v[176:179], v[32:47]
    ds_read_b64_tr_b16 v[172:173], v240 offset:43008
    v_mfma_f32_32x32x16_bf16 v[48:63], v[188:191], v[180:183], v[48:63]
    ds_read_b64_tr_b16 v[174:175], v240 offset:43520
    s_waitcnt lgkmcnt(6)
    v_mfma_f32_32x32x16_bf16 v[64:79], v[200:203], v[192:195], 0
    ds_read_b128 v[176:179], v234 offset:0
    ds_read_b128 v[180:183], v234 offset:4096
    v_mfma_f32_32x32x16_bf16 v[80:95], v[200:203], v[196:199], 0
    ds_read_b64_tr_b16 v[184:185], v240 offset:36864
    ds_read_b64_tr_b16 v[186:187], v240 offset:37376
    v_mul_f32 v220, s39, v0
    v_mul_f32 v221, s39, v1
    v_mul_f32 v222, s39, v2
    v_mul_f32 v223, s39, v3
    v_mfma_f32_32x32x16_bf16 v[96:111], v[204:207], v[192:195], 0
    ds_read_b64_tr_b16 v[188:189], v240 offset:45056
    v_mul_f32 v224, s39, v4
    v_mul_f32 v225, s39, v5
    v_mul_f32 v226, s39, v6
    v_mul_f32 v227, s39, v7
    v_mfma_f32_32x32x16_bf16 v[112:127], v[204:207], v[196:199], 0
    ds_read_b64_tr_b16 v[190:191], v240 offset:45568
    v_exp_f32 v220, v220
    v_mul_f32 v0, v0, v32
    s_waitcnt lgkmcnt(6)
    v_mfma_f32_32x32x16_bf16 v[64:79], v[168:171], v[160:163], v[64:79]
    ds_read_b128 v[192:195], v235 offset:0
    ds_read_b128 v[196:199], v235 offset:4096
    v_exp_f32 v221, v221
    v_mul_f32 v1, v1, v33
    v_mfma_f32_32x32x16_bf16 v[80:95], v[168:171], v[164:167], v[80:95]
    ds_read_b64_tr_b16 v[200:201], v240 offset:38912
    ds_read_b64_tr_b16 v[202:203], v240 offset:39424
    v_exp_f32 v222, v222
    v_mul_f32 v2, v2, v34
    v_mfma_f32_32x32x16_bf16 v[96:111], v[172:175], v[160:163], v[96:111]
    ds_read_b64_tr_b16 v[204:205], v240 offset:47104
    v_exp_f32 v223, v223
    v_mul_f32 v3, v3, v35
    v_mfma_f32_32x32x16_bf16 v[112:127], v[172:175], v[164:167], v[112:127]
    ds_read_b64_tr_b16 v[206:207], v240 offset:47616
    v_exp_f32 v224, v224
    v_mul_f32 v4, v4, v36
    s_waitcnt lgkmcnt(6)
    v_mfma_f32_32x32x16_bf16 v[64:79], v[184:187], v[176:179], v[64:79]
    ds_read_b128 v[160:163], v232 offset:16384
    ds_read_b128 v[164:167], v232 offset:20480
    v_exp_f32 v225, v225
    v_mul_f32 v5, v5, v37
    v_mfma_f32_32x32x16_bf16 v[80:95], v[184:187], v[180:183], v[80:95]
    v_exp_f32 v226, v226
    v_mul_f32 v6, v6, v38
    v_mfma_f32_32x32x16_bf16 v[96:111], v[188:191], v[176:179], v[96:111]
    s_waitcnt lgkmcnt(2)
    s_barrier
    ds_read_b64_tr_b16 v[168:169], v240 offset:0
    ds_read_b64_tr_b16 v[170:171], v240 offset:512
    v_exp_f32 v227, v227
    v_mul_f32 v7, v7, v39
    v_mfma_f32_32x32x16_bf16 v[112:127], v[188:191], v[180:183], v[112:127]
    ds_read_b64_tr_b16 v[172:173], v240 offset:8192
    ds_read_b64_tr_b16 v[174:175], v240 offset:8704
    v_add_f32 v220, 1.0, v220
    v_add_f32 v221, 1.0, v221
    v_add_f32 v222, 1.0, v222
    v_mfma_f32_32x32x16_bf16 v[64:79], v[200:203], v[192:195], v[64:79]
    ds_read_b128 v[176:179], v233 offset:16384
    ds_read_b128 v[180:183], v233 offset:20480
    v_add_f32 v223, 1.0, v223
    v_add_f32 v224, 1.0, v224
    v_add_f32 v225, 1.0, v225
    v_add_f32 v226, 1.0, v226
    v_mfma_f32_32x32x16_bf16 v[80:95], v[200:203], v[196:199], v[80:95]
    ds_read_b64_tr_b16 v[184:185], v240 offset:2048
    ds_read_b64_tr_b16 v[186:187], v240 offset:2560
    v_add_f32 v227, 1.0, v227
    v_rcp_f32 v220, v220
    v_mfma_f32_32x32x16_bf16 v[96:111], v[204:207], v[192:195], v[96:111]
    ds_read_b64_tr_b16 v[188:189], v240 offset:10240
    v_rcp_f32 v221, v221
    v_rcp_f32 v222, v222
    v_mfma_f32_32x32x16_bf16 v[112:127], v[204:207], v[196:199], v[112:127]
    ds_read_b64_tr_b16 v[190:191], v240 offset:10752
    v_rcp_f32 v223, v223
    v_rcp_f32 v224, v224
    s_waitcnt lgkmcnt(6)
    v_mfma_f32_32x32x16_bf16 v[64:79], v[168:171], v[160:163], v[64:79]
    ds_read_b128 v[192:195], v234 offset:16384
    ds_read_b128 v[196:199], v234 offset:20480
    v_rcp_f32 v225, v225
    v_rcp_f32 v226, v226
    v_mfma_f32_32x32x16_bf16 v[80:95], v[168:171], v[164:167], v[80:95]
    ds_read_b64_tr_b16 v[200:201], v240 offset:4096
    ds_read_b64_tr_b16 v[202:203], v240 offset:4608
    v_rcp_f32 v227, v227
    v_mul_f32 v0, v0, v220
    v_mul_f32 v1, v1, v221
    v_mfma_f32_32x32x16_bf16 v[96:111], v[172:175], v[160:163], v[96:111]
    ds_read_b64_tr_b16 v[204:205], v240 offset:12288
    v_mul_f32 v2, v2, v222
    v_mul_f32 v3, v3, v223
    v_mul_f32 v4, v4, v224
    v_mul_f32 v5, v5, v225
    v_mfma_f32_32x32x16_bf16 v[112:127], v[172:175], v[164:167], v[112:127]
    ds_read_b64_tr_b16 v[206:207], v240 offset:12800
    v_mul_f32 v6, v6, v226
    v_mul_f32 v7, v7, v227
    v_cvt_pk_bf16_f32 v32, v0, v1
    v_cvt_pk_bf16_f32 v33, v2, v3
    s_waitcnt lgkmcnt(6)
    v_mfma_f32_32x32x16_bf16 v[64:79], v[184:187], v[176:179], v[64:79]
    ds_read_b128 v[160:163], v235 offset:16384
    ds_read_b128 v[164:167], v235 offset:20480
    v_cvt_pk_bf16_f32 v34, v4, v5
    v_cvt_pk_bf16_f32 v35, v6, v7
    v_mul_f32 v220, s39, v8
    v_mul_f32 v221, s39, v9
    v_mfma_f32_32x32x16_bf16 v[80:95], v[184:187], v[180:183], v[80:95]
    ds_read_b64_tr_b16 v[168:169], v240 offset:6144
    ds_read_b64_tr_b16 v[170:171], v240 offset:6656
    s_add_u32 s33, s35, 0
    buffer_store_dwordx4 v[32:35], v254, s[20:23], s33 offen offset:0 sc1
    v_mul_f32 v222, s39, v10
    v_mul_f32 v223, s39, v11
    v_mfma_f32_32x32x16_bf16 v[96:111], v[188:191], v[176:179], v[96:111]
    ds_read_b64_tr_b16 v[172:173], v240 offset:14336
    v_mul_f32 v224, s39, v12
    v_mul_f32 v225, s39, v13
    v_mul_f32 v226, s39, v14
    v_mul_f32 v227, s39, v15
    v_mfma_f32_32x32x16_bf16 v[112:127], v[188:191], v[180:183], v[112:127]
    ds_read_b64_tr_b16 v[174:175], v240 offset:14848
    v_exp_f32 v220, v220
    v_mul_f32 v8, v8, v40
    s_waitcnt lgkmcnt(6)
    v_mfma_f32_32x32x16_bf16 v[64:79], v[200:203], v[192:195], v[64:79]
    ds_read_b128 v[176:179], v232 offset:32768
    ds_read_b128 v[180:183], v232 offset:36864
    v_exp_f32 v221, v221
    v_mul_f32 v9, v9, v41
    v_mfma_f32_32x32x16_bf16 v[80:95], v[200:203], v[196:199], v[80:95]
    v_exp_f32 v222, v222
    v_mul_f32 v10, v10, v42
    v_mfma_f32_32x32x16_bf16 v[96:111], v[204:207], v[192:195], v[96:111]
    s_waitcnt lgkmcnt(2)
    s_barrier
    ds_read_b64_tr_b16 v[184:185], v240 offset:16384
    ds_read_b64_tr_b16 v[186:187], v240 offset:16896
    v_exp_f32 v223, v223
    v_mul_f32 v11, v11, v43
    v_mfma_f32_32x32x16_bf16 v[112:127], v[204:207], v[196:199], v[112:127]
    ds_read_b64_tr_b16 v[188:189], v240 offset:24576
    ds_read_b64_tr_b16 v[190:191], v240 offset:25088
    v_exp_f32 v224, v224
    v_mul_f32 v12, v12, v44
    v_mfma_f32_32x32x16_bf16 v[64:79], v[168:171], v[160:163], v[64:79]
    ds_read_b128 v[192:195], v233 offset:32768
    ds_read_b128 v[196:199], v233 offset:36864
    v_exp_f32 v225, v225
    v_mul_f32 v13, v13, v45
    v_mfma_f32_32x32x16_bf16 v[80:95], v[168:171], v[164:167], v[80:95]
    ds_read_b64_tr_b16 v[200:201], v240 offset:18432
    ds_read_b64_tr_b16 v[202:203], v240 offset:18944
    v_exp_f32 v226, v226
    v_mul_f32 v14, v14, v46
    v_mfma_f32_32x32x16_bf16 v[96:111], v[172:175], v[160:163], v[96:111]
    ds_read_b64_tr_b16 v[204:205], v240 offset:26624
    v_exp_f32 v227, v227
    v_mul_f32 v15, v15, v47
    v_add_f32 v220, 1.0, v220
    v_mfma_f32_32x32x16_bf16 v[112:127], v[172:175], v[164:167], v[112:127]
    ds_read_b64_tr_b16 v[206:207], v240 offset:27136
    v_add_f32 v221, 1.0, v221
    v_add_f32 v222, 1.0, v222
    v_add_f32 v223, 1.0, v223
    v_add_f32 v224, 1.0, v224
    s_waitcnt lgkmcnt(6)
    v_mfma_f32_32x32x16_bf16 v[64:79], v[184:187], v[176:179], v[64:79]
    ds_read_b128 v[160:163], v234 offset:32768
    ds_read_b128 v[164:167], v234 offset:36864
    v_add_f32 v225, 1.0, v225
    v_add_f32 v226, 1.0, v226
    v_add_f32 v227, 1.0, v227
    v_mfma_f32_32x32x16_bf16 v[80:95], v[184:187], v[180:183], v[80:95]
    ds_read_b64_tr_b16 v[168:169], v240 offset:20480
    ds_read_b64_tr_b16 v[170:171], v240 offset:20992
    v_rcp_f32 v220, v220
    v_rcp_f32 v221, v221
    v_mfma_f32_32x32x16_bf16 v[96:111], v[188:191], v[176:179], v[96:111]
    ds_read_b64_tr_b16 v[172:173], v240 offset:28672
    v_rcp_f32 v222, v222
    v_rcp_f32 v223, v223
    v_mfma_f32_32x32x16_bf16 v[112:127], v[188:191], v[180:183], v[112:127]
    ds_read_b64_tr_b16 v[174:175], v240 offset:29184
    v_rcp_f32 v224, v224
    v_rcp_f32 v225, v225
    s_waitcnt lgkmcnt(6)
    v_mfma_f32_32x32x16_bf16 v[64:79], v[200:203], v[192:195], v[64:79]
    ds_read_b128 v[176:179], v235 offset:32768
    ds_read_b128 v[180:183], v235 offset:36864
    v_rcp_f32 v226, v226
    v_rcp_f32 v227, v227
    v_mfma_f32_32x32x16_bf16 v[80:95], v[200:203], v[196:199], v[80:95]
    ds_read_b64_tr_b16 v[184:185], v240 offset:22528
    ds_read_b64_tr_b16 v[186:187], v240 offset:23040
    v_mul_f32 v8, v8, v220
    v_mul_f32 v9, v9, v221
    v_mul_f32 v10, v10, v222
    v_mul_f32 v11, v11, v223
    v_mfma_f32_32x32x16_bf16 v[96:111], v[204:207], v[192:195], v[96:111]
    ds_read_b64_tr_b16 v[188:189], v240 offset:30720
    v_mul_f32 v12, v12, v224
    v_mul_f32 v13, v13, v225
    v_mul_f32 v14, v14, v226
    v_mul_f32 v15, v15, v227
    v_mfma_f32_32x32x16_bf16 v[112:127], v[204:207], v[196:199], v[112:127]
    ds_read_b64_tr_b16 v[190:191], v240 offset:31232
    v_cvt_pk_bf16_f32 v36, v8, v9
    v_cvt_pk_bf16_f32 v37, v10, v11
    v_cvt_pk_bf16_f32 v38, v12, v13
    v_cvt_pk_bf16_f32 v39, v14, v15
    s_waitcnt lgkmcnt(6)
    v_mfma_f32_32x32x16_bf16 v[64:79], v[168:171], v[160:163], v[64:79]
    ds_read_b128 v[192:195], v232 offset:49152
    ds_read_b128 v[196:199], v232 offset:53248
    v_mul_f32 v220, s39, v16
    v_mul_f32 v221, s39, v17
    v_mul_f32 v222, s39, v18
    v_mul_f32 v223, s39, v19
    v_mfma_f32_32x32x16_bf16 v[80:95], v[168:171], v[164:167], v[80:95]
    v_mul_f32 v224, s39, v20
    v_mul_f32 v225, s39, v21
    v_mul_f32 v226, s39, v22
    v_mul_f32 v227, s39, v23
    v_mfma_f32_32x32x16_bf16 v[96:111], v[172:175], v[160:163], v[96:111]
    s_waitcnt lgkmcnt(2)
    s_barrier
    ds_read_b64_tr_b16 v[200:201], v240 offset:32768
    ds_read_b64_tr_b16 v[202:203], v240 offset:33280
    v_exp_f32 v220, v220
    v_mul_f32 v16, v16, v48
    v_mfma_f32_32x32x16_bf16 v[112:127], v[172:175], v[164:167], v[112:127]
    ds_read_b64_tr_b16 v[204:205], v240 offset:40960
    ds_read_b64_tr_b16 v[206:207], v240 offset:41472
    v_exp_f32 v221, v221
    v_mul_f32 v17, v17, v49
    v_mfma_f32_32x32x16_bf16 v[64:79], v[184:187], v[176:179], v[64:79]
    ds_read_b128 v[160:163], v233 offset:49152
    ds_read_b128 v[164:167], v233 offset:53248
    v_exp_f32 v222, v222
    v_mul_f32 v18, v18, v50
    v_mfma_f32_32x32x16_bf16 v[80:95], v[184:187], v[180:183], v[80:95]
    ds_read_b64_tr_b16 v[168:169], v240 offset:34816
    ds_read_b64_tr_b16 v[170:171], v240 offset:35328
    v_exp_f32 v223, v223
    v_mul_f32 v19, v19, v51
    v_mfma_f32_32x32x16_bf16 v[96:111], v[188:191], v[176:179], v[96:111]
    ds_read_b64_tr_b16 v[172:173], v240 offset:43008
    v_exp_f32 v224, v224
    v_mul_f32 v20, v20, v52
    v_mfma_f32_32x32x16_bf16 v[112:127], v[188:191], v[180:183], v[112:127]
    ds_read_b64_tr_b16 v[174:175], v240 offset:43520
    v_exp_f32 v225, v225
    v_mul_f32 v21, v21, v53
    s_waitcnt lgkmcnt(6)
    v_mfma_f32_32x32x16_bf16 v[64:79], v[200:203], v[192:195], v[64:79]
    ds_read_b128 v[176:179], v234 offset:49152
    ds_read_b128 v[180:183], v234 offset:53248
    v_exp_f32 v226, v226
    v_mul_f32 v22, v22, v54
    v_mfma_f32_32x32x16_bf16 v[80:95], v[200:203], v[196:199], v[80:95]
    ds_read_b64_tr_b16 v[184:185], v240 offset:36864
    ds_read_b64_tr_b16 v[186:187], v240 offset:37376
    v_exp_f32 v227, v227
    v_mul_f32 v23, v23, v55
    v_add_f32 v220, 1.0, v220
    v_mfma_f32_32x32x16_bf16 v[96:111], v[204:207], v[192:195], v[96:111]
    ds_read_b64_tr_b16 v[188:189], v240 offset:45056
    s_add_u32 s33, s35, 0
    buffer_store_dwordx4 v[36:39], v254, s[20:23], s33 offen offset:1024 sc1
    v_add_f32 v221, 1.0, v221
    v_add_f32 v222, 1.0, v222
    v_mfma_f32_32x32x16_bf16 v[112:127], v[204:207], v[196:199], v[112:127]
    ds_read_b64_tr_b16 v[190:191], v240 offset:45568
    v_add_f32 v223, 1.0, v223
    v_add_f32 v224, 1.0, v224
    v_add_f32 v225, 1.0, v225
    v_add_f32 v226, 1.0, v226
    s_waitcnt lgkmcnt(6)
    v_mfma_f32_32x32x16_bf16 v[64:79], v[168:171], v[160:163], v[64:79]
    ds_read_b128 v[192:195], v235 offset:49152
    ds_read_b128 v[196:199], v235 offset:53248
    v_add_f32 v227, 1.0, v227
    v_rcp_f32 v220, v220
    v_mfma_f32_32x32x16_bf16 v[80:95], v[168:171], v[164:167], v[80:95]
    ds_read_b64_tr_b16 v[200:201], v240 offset:38912
    ds_read_b64_tr_b16 v[202:203], v240 offset:39424
    v_rcp_f32 v221, v221
    v_rcp_f32 v222, v222
    v_mfma_f32_32x32x16_bf16 v[96:111], v[172:175], v[160:163], v[96:111]
    ds_read_b64_tr_b16 v[204:205], v240 offset:47104
    v_rcp_f32 v223, v223
    v_rcp_f32 v224, v224
    v_mfma_f32_32x32x16_bf16 v[112:127], v[172:175], v[164:167], v[112:127]
    ds_read_b64_tr_b16 v[206:207], v240 offset:47616
    v_rcp_f32 v225, v225
    v_rcp_f32 v226, v226
    s_waitcnt lgkmcnt(6)
    v_mfma_f32_32x32x16_bf16 v[64:79], v[184:187], v[176:179], v[64:79]
    ds_read_b128 v[160:163], v236 offset:0
    ds_read_b128 v[164:167], v236 offset:4096
    v_rcp_f32 v227, v227
    v_mul_f32 v16, v16, v220
    v_mul_f32 v17, v17, v221
    v_mfma_f32_32x32x16_bf16 v[80:95], v[184:187], v[180:183], v[80:95]
    v_mul_f32 v18, v18, v222
    v_mul_f32 v19, v19, v223
    v_mul_f32 v20, v20, v224
    v_mul_f32 v21, v21, v225
    v_mfma_f32_32x32x16_bf16 v[96:111], v[188:191], v[176:179], v[96:111]
    s_waitcnt lgkmcnt(2)
    s_barrier
    ds_read_b64_tr_b16 v[168:169], v240 offset:0
    ds_read_b64_tr_b16 v[170:171], v240 offset:512
    v_mul_f32 v22, v22, v226
    v_mul_f32 v23, v23, v227
    v_cvt_pk_bf16_f32 v48, v16, v17
    v_mfma_f32_32x32x16_bf16 v[112:127], v[188:191], v[180:183], v[112:127]
    ds_read_b64_tr_b16 v[172:173], v240 offset:8192
    ds_read_b64_tr_b16 v[174:175], v240 offset:8704
    v_cvt_pk_bf16_f32 v49, v18, v19
    v_cvt_pk_bf16_f32 v50, v20, v21
    v_cvt_pk_bf16_f32 v51, v22, v23
    v_mfma_f32_32x32x16_bf16 v[64:79], v[200:203], v[192:195], v[64:79]
    ds_read_b128 v[176:179], v237 offset:0
    ds_read_b128 v[180:183], v237 offset:4096
    v_mul_f32 v220, s39, v24
    v_mul_f32 v221, s39, v25
    v_mul_f32 v222, s39, v26
    v_mul_f32 v223, s39, v27
    v_mfma_f32_32x32x16_bf16 v[80:95], v[200:203], v[196:199], v[80:95]
    ds_read_b64_tr_b16 v[184:185], v240 offset:2048
    ds_read_b64_tr_b16 v[186:187], v240 offset:2560
    v_mul_f32 v224, s39, v28
    v_mul_f32 v225, s39, v29
    v_mul_f32 v226, s39, v30
    v_mul_f32 v227, s39, v31
    v_mfma_f32_32x32x16_bf16 v[96:111], v[204:207], v[192:195], v[96:111]
    ds_read_b64_tr_b16 v[188:189], v240 offset:10240
    v_exp_f32 v220, v220
    v_mul_f32 v24, v24, v56
    v_mfma_f32_32x32x16_bf16 v[112:127], v[204:207], v[196:199], v[112:127]
    ds_read_b64_tr_b16 v[190:191], v240 offset:10752
    v_exp_f32 v221, v221
    v_mul_f32 v25, v25, v57
    s_waitcnt lgkmcnt(6)
    v_mfma_f32_32x32x16_bf16 v[64:79], v[168:171], v[160:163], v[64:79]
    ds_read_b128 v[192:195], v238 offset:0
    ds_read_b128 v[196:199], v238 offset:4096
    v_exp_f32 v222, v222
    v_mul_f32 v26, v26, v58
    v_mfma_f32_32x32x16_bf16 v[80:95], v[168:171], v[164:167], v[80:95]
    ds_read_b64_tr_b16 v[200:201], v240 offset:4096
    ds_read_b64_tr_b16 v[202:203], v240 offset:4608
    v_exp_f32 v223, v223
    v_mul_f32 v27, v27, v59
    v_mfma_f32_32x32x16_bf16 v[96:111], v[172:175], v[160:163], v[96:111]
    ds_read_b64_tr_b16 v[204:205], v240 offset:12288
    s_add_u32 s33, s35, 114688
    buffer_store_dwordx4 v[48:51], v254, s[20:23], s33 offen offset:0 sc1
    v_exp_f32 v224, v224
    v_mfma_f32_32x32x16_bf16 v[112:127], v[172:175], v[164:167], v[112:127]
    ds_read_b64_tr_b16 v[206:207], v240 offset:12800
    v_mul_f32 v28, v28, v60
    v_exp_f32 v225, v225
    v_mul_f32 v29, v29, v61
    s_waitcnt lgkmcnt(6)
    v_mfma_f32_32x32x16_bf16 v[64:79], v[184:187], v[176:179], v[64:79]
    ds_read_b128 v[160:163], v239 offset:0
    ds_read_b128 v[164:167], v239 offset:4096
    v_exp_f32 v226, v226
    v_mul_f32 v30, v30, v62
    v_mfma_f32_32x32x16_bf16 v[80:95], v[184:187], v[180:183], v[80:95]
    ds_read_b64_tr_b16 v[168:169], v240 offset:6144
    ds_read_b64_tr_b16 v[170:171], v240 offset:6656
    v_exp_f32 v227, v227
    v_mul_f32 v31, v31, v63
    v_add_f32 v220, 1.0, v220
    v_mfma_f32_32x32x16_bf16 v[96:111], v[188:191], v[176:179], v[96:111]
    ds_read_b64_tr_b16 v[172:173], v240 offset:14336
    v_add_f32 v221, 1.0, v221
    v_add_f32 v222, 1.0, v222
    v_add_f32 v223, 1.0, v223
    v_add_f32 v224, 1.0, v224
    v_mfma_f32_32x32x16_bf16 v[112:127], v[188:191], v[180:183], v[112:127]
    ds_read_b64_tr_b16 v[174:175], v240 offset:14848
    v_add_f32 v225, 1.0, v225
    v_add_f32 v226, 1.0, v226
    v_add_f32 v227, 1.0, v227
    s_waitcnt lgkmcnt(6)
    v_mfma_f32_32x32x16_bf16 v[64:79], v[200:203], v[192:195], v[64:79]
    ds_read_b128 v[176:179], v236 offset:16384
    ds_read_b128 v[180:183], v236 offset:20480
    v_rcp_f32 v220, v220
    v_rcp_f32 v221, v221
    v_mfma_f32_32x32x16_bf16 v[80:95], v[200:203], v[196:199], v[80:95]
    v_rcp_f32 v222, v222
    v_rcp_f32 v223, v223
    v_mfma_f32_32x32x16_bf16 v[96:111], v[204:207], v[192:195], v[96:111]
    s_waitcnt lgkmcnt(2)
    s_barrier
    ds_read_b64_tr_b16 v[184:185], v240 offset:16384
    ds_read_b64_tr_b16 v[186:187], v240 offset:16896
    v_rcp_f32 v224, v224
    v_mfma_f32_32x32x16_bf16 v[112:127], v[204:207], v[196:199], v[112:127]
    ds_read_b64_tr_b16 v[188:189], v240 offset:24576
    ds_read_b64_tr_b16 v[190:191], v240 offset:25088
    v_rcp_f32 v225, v225
    v_mfma_f32_32x32x16_bf16 v[64:79], v[168:171], v[160:163], v[64:79]
    ds_read_b128 v[192:195], v237 offset:16384
    ds_read_b128 v[196:199], v237 offset:20480
    v_rcp_f32 v226, v226
    v_rcp_f32 v227, v227
    v_mfma_f32_32x32x16_bf16 v[80:95], v[168:171], v[164:167], v[80:95]
    ds_read_b64_tr_b16 v[200:201], v240 offset:18432
    ds_read_b64_tr_b16 v[202:203], v240 offset:18944
    v_mul_f32 v24, v24, v220
    v_mul_f32 v25, v25, v221
    v_mul_f32 v26, v26, v222
    v_mul_f32 v27, v27, v223
    v_mfma_f32_32x32x16_bf16 v[96:111], v[172:175], v[160:163], v[96:111]
    ds_read_b64_tr_b16 v[204:205], v240 offset:26624
    v_mul_f32 v28, v28, v224
    v_mul_f32 v29, v29, v225
    v_mul_f32 v30, v30, v226
    v_mul_f32 v31, v31, v227
    v_mfma_f32_32x32x16_bf16 v[112:127], v[172:175], v[164:167], v[112:127]
    ds_read_b64_tr_b16 v[206:207], v240 offset:27136
    v_cvt_pk_bf16_f32 v52, v24, v25
    v_cvt_pk_bf16_f32 v53, v26, v27
    v_cvt_pk_bf16_f32 v54, v28, v29
    v_cvt_pk_bf16_f32 v55, v30, v31
    s_waitcnt lgkmcnt(6)
    v_mfma_f32_32x32x16_bf16 v[64:79], v[184:187], v[176:179], v[64:79]
    ds_read_b128 v[160:163], v238 offset:16384
    ds_read_b128 v[164:167], v238 offset:20480
    v_mfma_f32_32x32x16_bf16 v[80:95], v[184:187], v[180:183], v[80:95]
    ds_read_b64_tr_b16 v[168:169], v240 offset:20480
    ds_read_b64_tr_b16 v[170:171], v240 offset:20992
    v_mfma_f32_32x32x16_bf16 v[96:111], v[188:191], v[176:179], v[96:111]
    ds_read_b64_tr_b16 v[172:173], v240 offset:28672
    s_add_u32 s33, s35, 114688
    buffer_store_dwordx4 v[52:55], v254, s[20:23], s33 offen offset:1024 sc1
    v_mfma_f32_32x32x16_bf16 v[112:127], v[188:191], v[180:183], v[112:127]
    ds_read_b64_tr_b16 v[174:175], v240 offset:29184
    s_waitcnt lgkmcnt(6)
    v_mfma_f32_32x32x16_bf16 v[64:79], v[200:203], v[192:195], v[64:79]
    ds_read_b128 v[176:179], v239 offset:16384
    ds_read_b128 v[180:183], v239 offset:20480
    v_mfma_f32_32x32x16_bf16 v[80:95], v[200:203], v[196:199], v[80:95]
    ds_read_b64_tr_b16 v[184:185], v240 offset:22528
    ds_read_b64_tr_b16 v[186:187], v240 offset:23040
    v_mfma_f32_32x32x16_bf16 v[96:111], v[204:207], v[192:195], v[96:111]
    ds_read_b64_tr_b16 v[188:189], v240 offset:30720
    v_mfma_f32_32x32x16_bf16 v[112:127], v[204:207], v[196:199], v[112:127]
    ds_read_b64_tr_b16 v[190:191], v240 offset:31232
    s_waitcnt lgkmcnt(6)
    v_mfma_f32_32x32x16_bf16 v[64:79], v[168:171], v[160:163], v[64:79]
    ds_read_b128 v[192:195], v236 offset:32768
    ds_read_b128 v[196:199], v236 offset:36864
    v_mfma_f32_32x32x16_bf16 v[80:95], v[168:171], v[164:167], v[80:95]
    v_mfma_f32_32x32x16_bf16 v[96:111], v[172:175], v[160:163], v[96:111]
    s_waitcnt lgkmcnt(2)
    s_waitcnt vmcnt(0)
    s_barrier
    ds_read_b64_tr_b16 v[200:201], v240 offset:32768
    ds_read_b64_tr_b16 v[202:203], v240 offset:33280
    v_mfma_f32_32x32x16_bf16 v[112:127], v[172:175], v[164:167], v[112:127]
    ds_read_b64_tr_b16 v[204:205], v240 offset:40960
    ds_read_b64_tr_b16 v[206:207], v240 offset:41472
    v_mfma_f32_32x32x16_bf16 v[64:79], v[184:187], v[176:179], v[64:79]
    ds_read_b128 v[160:163], v237 offset:32768
    ds_read_b128 v[164:167], v237 offset:36864
    v_mfma_f32_32x32x16_bf16 v[80:95], v[184:187], v[180:183], v[80:95]
    ds_read_b64_tr_b16 v[168:169], v240 offset:34816
    ds_read_b64_tr_b16 v[170:171], v240 offset:35328
    v_mfma_f32_32x32x16_bf16 v[96:111], v[188:191], v[176:179], v[96:111]
    ds_read_b64_tr_b16 v[172:173], v240 offset:43008
    v_mfma_f32_32x32x16_bf16 v[112:127], v[188:191], v[180:183], v[112:127]
    ds_read_b64_tr_b16 v[174:175], v240 offset:43520
    s_waitcnt lgkmcnt(6)
    v_mfma_f32_32x32x16_bf16 v[64:79], v[200:203], v[192:195], v[64:79]
    ds_read_b128 v[176:179], v238 offset:32768
    ds_read_b128 v[180:183], v238 offset:36864
    v_mfma_f32_32x32x16_bf16 v[80:95], v[200:203], v[196:199], v[80:95]
    ds_read_b64_tr_b16 v[184:185], v240 offset:36864
    ds_read_b64_tr_b16 v[186:187], v240 offset:37376
    v_mfma_f32_32x32x16_bf16 v[96:111], v[204:207], v[192:195], v[96:111]
    ds_read_b64_tr_b16 v[188:189], v240 offset:45056
    v_mfma_f32_32x32x16_bf16 v[112:127], v[204:207], v[196:199], v[112:127]
    ds_read_b64_tr_b16 v[190:191], v240 offset:45568
    s_waitcnt lgkmcnt(6)
    v_mfma_f32_32x32x16_bf16 v[64:79], v[168:171], v[160:163], v[64:79]
    ds_read_b128 v[192:195], v239 offset:32768
    ds_read_b128 v[196:199], v239 offset:36864
    v_mfma_f32_32x32x16_bf16 v[80:95], v[168:171], v[164:167], v[80:95]
    ds_read_b64_tr_b16 v[200:201], v240 offset:38912
    ds_read_b64_tr_b16 v[202:203], v240 offset:39424
    v_mfma_f32_32x32x16_bf16 v[96:111], v[172:175], v[160:163], v[96:111]
    ds_read_b64_tr_b16 v[204:205], v240 offset:47104
    v_mfma_f32_32x32x16_bf16 v[112:127], v[172:175], v[164:167], v[112:127]
    ds_read_b64_tr_b16 v[206:207], v240 offset:47616
    s_waitcnt lgkmcnt(6)
    v_mfma_f32_32x32x16_bf16 v[64:79], v[184:187], v[176:179], v[64:79]
    v_mfma_f32_32x32x16_bf16 v[80:95], v[184:187], v[180:183], v[80:95]
    v_mfma_f32_32x32x16_bf16 v[96:111], v[188:191], v[176:179], v[96:111]
    v_mfma_f32_32x32x16_bf16 v[112:127], v[188:191], v[180:183], v[112:127]
    s_waitcnt lgkmcnt(0)
    v_mfma_f32_32x32x16_bf16 v[64:79], v[200:203], v[192:195], v[64:79]
    v_mfma_f32_32x32x16_bf16 v[80:95], v[200:203], v[196:199], v[80:95]
    v_mfma_f32_32x32x16_bf16 v[96:111], v[204:207], v[192:195], v[96:111]
    v_mfma_f32_32x32x16_bf16 v[112:127], v[204:207], v[196:199], v[112:127]
    v_mov_b32 v228, s39
    v_mov_b32 v229, s39
    v_mov_b32 v230, 1.0
    v_mov_b32 v231, 1.0
    s_nop 4
    v_pk_mul_f32 v[220:221], v[64:65], v[228:229]
    v_pk_mul_f32 v[222:223], v[66:67], v[228:229]
    v_pk_mul_f32 v[224:225], v[68:69], v[228:229]
    v_pk_mul_f32 v[226:227], v[70:71], v[228:229]
    v_exp_f32 v220, v220
    v_exp_f32 v221, v221
    v_pk_mul_f32 v[64:65], v[64:65], v[96:97]
    v_exp_f32 v222, v222
    v_exp_f32 v223, v223
    v_pk_mul_f32 v[66:67], v[66:67], v[98:99]
    v_exp_f32 v224, v224
    v_exp_f32 v225, v225
    v_pk_mul_f32 v[68:69], v[68:69], v[100:101]
    v_exp_f32 v226, v226
    v_exp_f32 v227, v227
    v_pk_mul_f32 v[70:71], v[70:71], v[102:103]
    v_pk_add_f32 v[220:221], v[220:221], v[230:231]
    v_pk_add_f32 v[222:223], v[222:223], v[230:231]
    v_pk_add_f32 v[224:225], v[224:225], v[230:231]
    v_pk_add_f32 v[226:227], v[226:227], v[230:231]
    v_rcp_f32 v220, v220
    v_rcp_f32 v221, v221
    v_rcp_f32 v222, v222
    v_rcp_f32 v223, v223
    v_rcp_f32 v224, v224
    v_rcp_f32 v225, v225
    v_rcp_f32 v226, v226
    v_rcp_f32 v227, v227
    v_pk_mul_f32 v[64:65], v[64:65], v[220:221]
    v_pk_mul_f32 v[66:67], v[66:67], v[222:223]
    v_pk_mul_f32 v[68:69], v[68:69], v[224:225]
    v_pk_mul_f32 v[70:71], v[70:71], v[226:227]
    v_cvt_pk_bf16_f32 v96, v64, v65
    v_cvt_pk_bf16_f32 v97, v66, v67
    v_cvt_pk_bf16_f32 v98, v68, v69
    v_cvt_pk_bf16_f32 v99, v70, v71
    s_add_u32 s33, s35, 49152
    buffer_store_dwordx4 v[96:99], v254, s[20:23], s33 offen offset:0 sc1
    v_pk_mul_f32 v[220:221], v[72:73], v[228:229]
    v_pk_mul_f32 v[222:223], v[74:75], v[228:229]
    v_pk_mul_f32 v[224:225], v[76:77], v[228:229]
    v_pk_mul_f32 v[226:227], v[78:79], v[228:229]
    v_exp_f32 v220, v220
    v_exp_f32 v221, v221
    v_pk_mul_f32 v[72:73], v[72:73], v[104:105]
    v_exp_f32 v222, v222
    v_exp_f32 v223, v223
    v_pk_mul_f32 v[74:75], v[74:75], v[106:107]
    v_exp_f32 v224, v224
    v_exp_f32 v225, v225
    v_pk_mul_f32 v[76:77], v[76:77], v[108:109]
    v_exp_f32 v226, v226
    v_exp_f32 v227, v227
    v_pk_mul_f32 v[78:79], v[78:79], v[110:111]
    v_pk_add_f32 v[220:221], v[220:221], v[230:231]
    v_pk_add_f32 v[222:223], v[222:223], v[230:231]
    v_pk_add_f32 v[224:225], v[224:225], v[230:231]
    v_pk_add_f32 v[226:227], v[226:227], v[230:231]
    v_rcp_f32 v220, v220
    v_rcp_f32 v221, v221
    v_rcp_f32 v222, v222
    v_rcp_f32 v223, v223
    v_rcp_f32 v224, v224
    v_rcp_f32 v225, v225
    v_rcp_f32 v226, v226
    v_rcp_f32 v227, v227
    v_pk_mul_f32 v[72:73], v[72:73], v[220:221]
    v_pk_mul_f32 v[74:75], v[74:75], v[222:223]
    v_pk_mul_f32 v[76:77], v[76:77], v[224:225]
    v_pk_mul_f32 v[78:79], v[78:79], v[226:227]
    v_cvt_pk_bf16_f32 v100, v72, v73
    v_cvt_pk_bf16_f32 v101, v74, v75
    v_cvt_pk_bf16_f32 v102, v76, v77
    v_cvt_pk_bf16_f32 v103, v78, v79
    s_add_u32 s33, s35, 49152
    buffer_store_dwordx4 v[100:103], v254, s[20:23], s33 offen offset:1024 sc1
    v_pk_mul_f32 v[220:221], v[80:81], v[228:229]
    v_pk_mul_f32 v[222:223], v[82:83], v[228:229]
    v_pk_mul_f32 v[224:225], v[84:85], v[228:229]
    v_pk_mul_f32 v[226:227], v[86:87], v[228:229]
    v_exp_f32 v220, v220
    v_exp_f32 v221, v221
    v_pk_mul_f32 v[80:81], v[80:81], v[112:113]
    v_exp_f32 v222, v222
    v_exp_f32 v223, v223
    v_pk_mul_f32 v[82:83], v[82:83], v[114:115]
    v_exp_f32 v224, v224
    v_exp_f32 v225, v225
    v_pk_mul_f32 v[84:85], v[84:85], v[116:117]
    v_exp_f32 v226, v226
    v_exp_f32 v227, v227
    v_pk_mul_f32 v[86:87], v[86:87], v[118:119]
    v_pk_add_f32 v[220:221], v[220:221], v[230:231]
    v_pk_add_f32 v[222:223], v[222:223], v[230:231]
    v_pk_add_f32 v[224:225], v[224:225], v[230:231]
    v_pk_add_f32 v[226:227], v[226:227], v[230:231]
    v_rcp_f32 v220, v220
    v_rcp_f32 v221, v221
    v_rcp_f32 v222, v222
    v_rcp_f32 v223, v223
    v_rcp_f32 v224, v224
    v_rcp_f32 v225, v225
    v_rcp_f32 v226, v226
    v_rcp_f32 v227, v227
    v_pk_mul_f32 v[80:81], v[80:81], v[220:221]
    v_pk_mul_f32 v[82:83], v[82:83], v[222:223]
    v_pk_mul_f32 v[84:85], v[84:85], v[224:225]
    v_pk_mul_f32 v[86:87], v[86:87], v[226:227]
    v_cvt_pk_bf16_f32 v112, v80, v81
    v_cvt_pk_bf16_f32 v113, v82, v83
    v_cvt_pk_bf16_f32 v114, v84, v85
    v_cvt_pk_bf16_f32 v115, v86, v87
    s_add_u32 s33, s35, 163840
    buffer_store_dwordx4 v[112:115], v254, s[20:23], s33 offen offset:0 sc1
    v_pk_mul_f32 v[220:221], v[88:89], v[228:229]
    v_pk_mul_f32 v[222:223], v[90:91], v[228:229]
    v_pk_mul_f32 v[224:225], v[92:93], v[228:229]
    v_pk_mul_f32 v[226:227], v[94:95], v[228:229]
    v_exp_f32 v220, v220
    v_exp_f32 v221, v221
    v_pk_mul_f32 v[88:89], v[88:89], v[120:121]
    v_exp_f32 v222, v222
    v_exp_f32 v223, v223
    v_pk_mul_f32 v[90:91], v[90:91], v[122:123]
    v_exp_f32 v224, v224
    v_exp_f32 v225, v225
    v_pk_mul_f32 v[92:93], v[92:93], v[124:125]
    v_exp_f32 v226, v226
    v_exp_f32 v227, v227
    v_pk_mul_f32 v[94:95], v[94:95], v[126:127]
    v_pk_add_f32 v[220:221], v[220:221], v[230:231]
    v_pk_add_f32 v[222:223], v[222:223], v[230:231]
    v_pk_add_f32 v[224:225], v[224:225], v[230:231]
    v_pk_add_f32 v[226:227], v[226:227], v[230:231]
    v_rcp_f32 v220, v220
    v_rcp_f32 v221, v221
    v_rcp_f32 v222, v222
    v_rcp_f32 v223, v223
    v_rcp_f32 v224, v224
    v_rcp_f32 v225, v225
    v_rcp_f32 v226, v226
    v_rcp_f32 v227, v227
    v_pk_mul_f32 v[88:89], v[88:89], v[220:221]
    v_pk_mul_f32 v[90:91], v[90:91], v[222:223]
    v_pk_mul_f32 v[92:93], v[92:93], v[224:225]
    v_pk_mul_f32 v[94:95], v[94:95], v[226:227]
    v_cvt_pk_bf16_f32 v116, v88, v89
    v_cvt_pk_bf16_f32 v117, v90, v91
    v_cvt_pk_bf16_f32 v118, v92, v93
    v_cvt_pk_bf16_f32 v119, v94, v95
    s_add_u32 s33, s35, 163840
    buffer_store_dwordx4 v[116:119], v254, s[20:23], s33 offen offset:1024 sc1
    s_branch L_k12_attn
L_k12_compY:
    s_lshr_b32 s29, s28, 1
    s_and_b32 s30, s28, 1
    s_lshl_b32 s34, s25, 1
    s_add_u32 s34, s34, s29
    s_lshl_b32 s34, s34, 1
    v_and_b32 v250, 31, v253
    v_lshrrev_b32 v251, 5, v253
    v_bfe_u32 v252, v253, 1, 3
    v_xor_b32 v252, v252, v251
    v_lshlrev_b32 v250, 7, v250
    s_lshl_b32 s32, s29, 13
    v_add_u32 v250, s32, v250
    v_xor_b32 v232, 0, v252
    v_lshl_add_u32 v232, v232, 4, v250
    v_add_u32 v236, 65536, v232
    v_xor_b32 v233, 2, v252
    v_lshl_add_u32 v233, v233, 4, v250
    v_add_u32 v237, 65536, v233
    v_xor_b32 v234, 4, v252
    v_lshl_add_u32 v234, v234, 4, v250
    v_add_u32 v238, 65536, v234
    v_xor_b32 v235, 6, v252
    v_lshl_add_u32 v235, v235, 4, v250
    v_add_u32 v239, 65536, v235
    v_bfe_u32 v250, v253, 2, 2
    v_lshl_add_u32 v250, v251, 3, v250
    v_bfe_u32 v252, v253, 4, 1
    v_lshlrev_b32 v252, 5, v252
    v_and_b32 v251, 3, v253
    v_lshl_add_u32 v252, v251, 3, v252
    v_lshl_add_u32 v252, v250, 7, v252
    v_bfe_u32 v251, v253, 3, 1
    v_xor_b32 v251, s30, v251
    v_lshl_add_u32 v240, v251, 6, v252
    v_add_u32 v240, 114688, v240
    s_mov_b32 s39, 0xbfb8aa3b
    s_lshl_b32 s31, s26, 1
    s_add_u32 s31, s31, s30
    s_mul_i32 s35, s34, 114688
    s_lshl_b32 s33, s31, 11
    s_add_u32 s35, s35, s33
    s_add_u32 s35, s35, 6291456
    s_sub_u32 s33, s26, 12
    s_lshl_b32 s32, s33, 2
    s_add_u32 s32, s32, s30
    s_lshl_b32 s32, s32, 6
    s_add_u32 s32, s32, s34
    s_lshl_b32 s48, s32, 12
    s_add_u32 s48, s48, 2099200
    s_and_b32 s33, s31, 15
    s_lshl_b32 s33, s33, 6
    s_add_u32 s33, s33, s34
    s_cmp_lt_u32 s31, 16
    s_cselect_b32 s37, 11, 12
    s_cselect_b32 s36, 0, 2097152
    s_cselect_b32 s38, 0x3e8b97f6, 1.0
    s_lshl_b32 s37, 1, s37
    s_mul_i32 s33, s33, s37
    s_add_u32 s36, s36, s33
    v_cmp_gt_u32 vcc, 32, v253
    v_mov_b32 v250, s38
    v_mov_b32 v251, 0
    v_cndmask_b32 v241, v251, v250, vcc
    v_and_b32 v250, 31, v253
    v_cmp_eq_u32 vcc, 28, v250
    v_mov_b32 v252, 0x3f803f80
    s_nop 0
    v_cndmask_b32 v242, v251, v252, vcc
    v_cmp_le_u32 s[40:41], 28, v250
    s_waitcnt lgkmcnt(0)
    s_mov_b32 s20, s90
    s_mov_b32 s21, s91
    s_mov_b32 s22, 19922944
    s_mov_b32 s23, 0x20000
    s_mov_b32 s64, s84
    s_mov_b32 s65, s85
    s_mov_b32 s66, 1605632
    s_mov_b32 s67, 0x20000
    s_barrier
    ds_read_b128 v[160:163], v232 offset:0
    ds_read_b128 v[164:167], v232 offset:4096
    ds_read_b64_tr_b16 v[168:169], v240 offset:0
    ds_read_b64_tr_b16 v[170:171], v240 offset:512
    ds_read_b64_tr_b16 v[172:173], v240 offset:8192
    ds_read_b64_tr_b16 v[174:175], v240 offset:8704
    ds_read_b128 v[176:179], v233 offset:0
    ds_read_b128 v[180:183], v233 offset:4096
    ds_read_b64_tr_b16 v[184:185], v240 offset:2048
    ds_read_b64_tr_b16 v[186:187], v240 offset:2560
    ds_read_b64_tr_b16 v[188:189], v240 offset:10240
    ds_read_b64_tr_b16 v[190:191], v240 offset:10752
    s_waitcnt lgkmcnt(6)
    v_mfma_f32_32x32x16_bf16 v[0:15], v[160:163], v[168:171], 0
    ds_read_b128 v[192:195], v234 offset:0
    ds_read_b128 v[196:199], v234 offset:4096
    v_mfma_f32_32x32x16_bf16 v[16:31], v[164:167], v[168:171], 0
    ds_read_b64_tr_b16 v[200:201], v240 offset:4096
    ds_read_b64_tr_b16 v[202:203], v240 offset:4608
    v_mfma_f32_32x32x16_bf16 v[32:47], v[160:163], v[172:175], 0
    ds_read_b64_tr_b16 v[204:205], v240 offset:12288
    v_mfma_f32_32x32x16_bf16 v[48:63], v[164:167], v[172:175], 0
    ds_read_b64_tr_b16 v[206:207], v240 offset:12800
    s_waitcnt lgkmcnt(6)
    v_mfma_f32_32x32x16_bf16 v[0:15], v[176:179], v[184:187], v[0:15]
    ds_read_b128 v[160:163], v235 offset:0
    ds_read_b128 v[164:167], v235 offset:4096
    v_mfma_f32_32x32x16_bf16 v[16:31], v[180:183], v[184:187], v[16:31]
    ds_read_b64_tr_b16 v[168:169], v240 offset:6144
    ds_read_b64_tr_b16 v[170:171], v240 offset:6656
    v_mfma_f32_32x32x16_bf16 v[32:47], v[176:179], v[188:191], v[32:47]
    ds_read_b64_tr_b16 v[172:173], v240 offset:14336
    v_mfma_f32_32x32x16_bf16 v[48:63], v[180:183], v[188:191], v[48:63]
    ds_read_b64_tr_b16 v[174:175], v240 offset:14848
    s_waitcnt lgkmcnt(6)
    v_mfma_f32_32x32x16_bf16 v[0:15], v[192:195], v[200:203], v[0:15]
    v_mfma_f32_32x32x16_bf16 v[16:31], v[196:199], v[200:203], v[16:31]
    s_waitcnt lgkmcnt(0)
    s_barrier
    ds_read_b128 v[176:179], v232 offset:16384
    v_mfma_f32_32x32x16_bf16 v[32:47], v[192:195], v[204:207], v[32:47]
    ds_read_b128 v[180:183], v232 offset:20480
    ds_read_b64_tr_b16 v[184:185], v240 offset:16384
    ds_read_b64_tr_b16 v[186:187], v240 offset:16896
    v_mfma_f32_32x32x16_bf16 v[48:63], v[196:199], v[204:207], v[48:63]
    ds_read_b64_tr_b16 v[188:189], v240 offset:24576
    ds_read_b64_tr_b16 v[190:191], v240 offset:25088
    v_mfma_f32_32x32x16_bf16 v[0:15], v[160:163], v[168:171], v[0:15]
    ds_read_b128 v[192:195], v233 offset:16384
    ds_read_b128 v[196:199], v233 offset:20480
    v_mfma_f32_32x32x16_bf16 v[16:31], v[164:167], v[168:171], v[16:31]
    ds_read_b64_tr_b16 v[200:201], v240 offset:18432
    ds_read_b64_tr_b16 v[202:203], v240 offset:18944
    v_mfma_f32_32x32x16_bf16 v[32:47], v[160:163], v[172:175], v[32:47]
    ds_read_b64_tr_b16 v[204:205], v240 offset:26624
    v_mfma_f32_32x32x16_bf16 v[48:63], v[164:167], v[172:175], v[48:63]
    ds_read_b64_tr_b16 v[206:207], v240 offset:27136
    s_waitcnt lgkmcnt(6)
    v_mfma_f32_32x32x16_bf16 v[0:15], v[176:179], v[184:187], v[0:15]
    ds_read_b128 v[160:163], v234 offset:16384
    ds_read_b128 v[164:167], v234 offset:20480
    v_mfma_f32_32x32x16_bf16 v[16:31], v[180:183], v[184:187], v[16:31]
    ds_read_b64_tr_b16 v[168:169], v240 offset:20480
    ds_read_b64_tr_b16 v[170:171], v240 offset:20992
    v_mfma_f32_32x32x16_bf16 v[32:47], v[176:179], v[188:191], v[32:47]
    ds_read_b64_tr_b16 v[172:173], v240 offset:28672
    s_mov_b32 s55, 0x20000
    s_mov_b32 s54, 1605632
    s_and_b32 s32, s28, 1
    s_cmp_eq_u32 s32, 0
    s_cselect_b32 s52, s80, s82
    s_cselect_b32 s53, s81, s83
    s_and_b32 s33, s25, 7
    s_lshl_b32 s33, s33, 1
    s_lshr_b32 s31, s28, 1
    s_add_u32 s33, s33, s31
    v_min_u32 v250, 27, v253
    s_mov_b32 s54, 1204224
    s_mov_b32 s52, s74
    s_mov_b32 s53, s75
    s_mul_i32 s33, s33, 75264
    s_mul_i32 s32, s32, 116
    s_add_u32 s33, s33, s32
    s_mul_i32 s32, s26, 112
    v_mul_u32_u24 v252, 2688, v250
    s_add_u32 s33, s33, s32
    buffer_load_dword v243, v252, s[52:55], s33 offen offset:0
    v_mfma_f32_32x32x16_bf16 v[48:63], v[180:183], v[188:191], v[48:63]
    ds_read_b64_tr_b16 v[174:175], v240 offset:29184
    s_waitcnt lgkmcnt(6)
    v_mfma_f32_32x32x16_bf16 v[0:15], v[192:195], v[200:203], v[0:15]
    ds_read_b128 v[176:179], v235 offset:16384
    ds_read_b128 v[180:183], v235 offset:20480
    v_mfma_f32_32x32x16_bf16 v[16:31], v[196:199], v[200:203], v[16:31]
    ds_read_b64_tr_b16 v[184:185], v240 offset:22528
    ds_read_b64_tr_b16 v[186:187], v240 offset:23040
    v_mfma_f32_32x32x16_bf16 v[32:47], v[192:195], v[204:207], v[32:47]
    ds_read_b64_tr_b16 v[188:189], v240 offset:30720
    v_mfma_f32_32x32x16_bf16 v[48:63], v[196:199], v[204:207], v[48:63]
    ds_read_b64_tr_b16 v[190:191], v240 offset:31232
    s_waitcnt lgkmcnt(6)
    v_mfma_f32_32x32x16_bf16 v[0:15], v[160:163], v[168:171], v[0:15]
    v_mfma_f32_32x32x16_bf16 v[16:31], v[164:167], v[168:171], v[16:31]
    s_waitcnt lgkmcnt(0)
    s_barrier
    ds_read_b128 v[192:195], v232 offset:32768
    v_mfma_f32_32x32x16_bf16 v[32:47], v[160:163], v[172:175], v[32:47]
    ds_read_b128 v[196:199], v232 offset:36864
    ds_read_b64_tr_b16 v[200:201], v240 offset:32768
    ds_read_b64_tr_b16 v[202:203], v240 offset:33280
    v_mfma_f32_32x32x16_bf16 v[48:63], v[164:167], v[172:175], v[48:63]
    ds_read_b64_tr_b16 v[204:205], v240 offset:40960
    ds_read_b64_tr_b16 v[206:207], v240 offset:41472
    v_mfma_f32_32x32x16_bf16 v[0:15], v[176:179], v[184:187], v[0:15]
    ds_read_b128 v[160:163], v233 offset:32768
    ds_read_b128 v[164:167], v233 offset:36864
    v_mfma_f32_32x32x16_bf16 v[16:31], v[180:183], v[184:187], v[16:31]
    ds_read_b64_tr_b16 v[168:169], v240 offset:34816
    ds_read_b64_tr_b16 v[170:171], v240 offset:35328
    v_mfma_f32_32x32x16_bf16 v[32:47], v[176:179], v[188:191], v[32:47]
    ds_read_b64_tr_b16 v[172:173], v240 offset:43008
    v_mfma_f32_32x32x16_bf16 v[48:63], v[180:183], v[188:191], v[48:63]
    ds_read_b64_tr_b16 v[174:175], v240 offset:43520
    s_waitcnt lgkmcnt(6)
    v_mfma_f32_32x32x16_bf16 v[0:15], v[192:195], v[200:203], v[0:15]
    ds_read_b128 v[176:179], v234 offset:32768
    ds_read_b128 v[180:183], v234 offset:36864
    v_mfma_f32_32x32x16_bf16 v[16:31], v[196:199], v[200:203], v[16:31]
    ds_read_b64_tr_b16 v[184:185], v240 offset:36864
    ds_read_b64_tr_b16 v[186:187], v240 offset:37376
    v_mfma_f32_32x32x16_bf16 v[32:47], v[192:195], v[204:207], v[32:47]
    ds_read_b64_tr_b16 v[188:189], v240 offset:45056
    v_mfma_f32_32x32x16_bf16 v[48:63], v[196:199], v[204:207], v[48:63]
    ds_read_b64_tr_b16 v[190:191], v240 offset:45568
    s_waitcnt lgkmcnt(6)
    v_mfma_f32_32x32x16_bf16 v[0:15], v[160:163], v[168:171], v[0:15]
    ds_read_b128 v[192:195], v235 offset:32768
    ds_read_b128 v[196:199], v235 offset:36864
    v_mfma_f32_32x32x16_bf16 v[16:31], v[164:167], v[168:171], v[16:31]
    ds_read_b64_tr_b16 v[200:201], v240 offset:38912
    ds_read_b64_tr_b16 v[202:203], v240 offset:39424
    v_mfma_f32_32x32x16_bf16 v[32:47], v[160:163], v[172:175], v[32:47]
    ds_read_b64_tr_b16 v[204:205], v240 offset:47104
    v_mfma_f32_32x32x16_bf16 v[48:63], v[164:167], v[172:175], v[48:63]
    ds_read_b64_tr_b16 v[206:207], v240 offset:47616
    s_waitcnt lgkmcnt(6)
    v_mfma_f32_32x32x16_bf16 v[0:15], v[176:179], v[184:187], v[0:15]
    v_mfma_f32_32x32x16_bf16 v[16:31], v[180:183], v[184:187], v[16:31]
    s_waitcnt lgkmcnt(0)
    s_barrier
    ds_read_b128 v[160:163], v232 offset:49152
    v_mfma_f32_32x32x16_bf16 v[32:47], v[176:179], v[188:191], v[32:47]
    ds_read_b128 v[164:167], v232 offset:53248
    ds_read_b64_tr_b16 v[168:169], v240 offset:0
    ds_read_b64_tr_b16 v[170:171], v240 offset:512
    v_mfma_f32_32x32x16_bf16 v[48:63], v[180:183], v[188:191], v[48:63]
    ds_read_b64_tr_b16 v[172:173], v240 offset:8192
    ds_read_b64_tr_b16 v[174:175], v240 offset:8704
    v_mfma_f32_32x32x16_bf16 v[0:15], v[192:195], v[200:203], v[0:15]
    ds_read_b128 v[176:179], v233 offset:49152
    ds_read_b128 v[180:183], v233 offset:53248
    v_mfma_f32_32x32x16_bf16 v[16:31], v[196:199], v[200:203], v[16:31]
    ds_read_b64_tr_b16 v[184:185], v240 offset:2048
    ds_read_b64_tr_b16 v[186:187], v240 offset:2560
    v_mfma_f32_32x32x16_bf16 v[32:47], v[192:195], v[204:207], v[32:47]
    ds_read_b64_tr_b16 v[188:189], v240 offset:10240
    v_mfma_f32_32x32x16_bf16 v[48:63], v[196:199], v[204:207], v[48:63]
    ds_read_b64_tr_b16 v[190:191], v240 offset:10752
    s_waitcnt lgkmcnt(6)
    v_mfma_f32_32x32x16_bf16 v[0:15], v[160:163], v[168:171], v[0:15]
    ds_read_b128 v[192:195], v234 offset:49152
    ds_read_b128 v[196:199], v234 offset:53248
    v_mfma_f32_32x32x16_bf16 v[16:31], v[164:167], v[168:171], v[16:31]
    ds_read_b64_tr_b16 v[200:201], v240 offset:4096
    ds_read_b64_tr_b16 v[202:203], v240 offset:4608
    v_mfma_f32_32x32x16_bf16 v[32:47], v[160:163], v[172:175], v[32:47]
    ds_read_b64_tr_b16 v[204:205], v240 offset:12288
    v_mfma_f32_32x32x16_bf16 v[48:63], v[164:167], v[172:175], v[48:63]
    ds_read_b64_tr_b16 v[206:207], v240 offset:12800
    s_waitcnt lgkmcnt(6)
    v_mfma_f32_32x32x16_bf16 v[0:15], v[176:179], v[184:187], v[0:15]
    ds_read_b128 v[160:163], v235 offset:49152
    ds_read_b128 v[164:167], v235 offset:53248
    v_mfma_f32_32x32x16_bf16 v[16:31], v[180:183], v[184:187], v[16:31]
    ds_read_b64_tr_b16 v[168:169], v240 offset:6144
    ds_read_b64_tr_b16 v[170:171], v240 offset:6656
    v_mfma_f32_32x32x16_bf16 v[32:47], v[176:179], v[188:191], v[32:47]
    ds_read_b64_tr_b16 v[172:173], v240 offset:14336
    v_mfma_f32_32x32x16_bf16 v[48:63], v[180:183], v[188:191], v[48:63]
    ds_read_b64_tr_b16 v[174:175], v240 offset:14848
    s_waitcnt lgkmcnt(6)
    v_mfma_f32_32x32x16_bf16 v[0:15], v[192:195], v[200:203], v[0:15]
    v_mfma_f32_32x32x16_bf16 v[16:31], v[196:199], v[200:203], v[16:31]
    s_waitcnt lgkmcnt(0)
    s_barrier
    ds_read_b128 v[176:179], v236 offset:0
    v_mfma_f32_32x32x16_bf16 v[32:47], v[192:195], v[204:207], v[32:47]
    ds_read_b128 v[180:183], v236 offset:4096
    ds_read_b64_tr_b16 v[184:185], v240 offset:16384
    ds_read_b64_tr_b16 v[186:187], v240 offset:16896
    v_mfma_f32_32x32x16_bf16 v[48:63], v[196:199], v[204:207], v[48:63]
    ds_read_b64_tr_b16 v[188:189], v240 offset:24576
    ds_read_b64_tr_b16 v[190:191], v240 offset:25088
    v_mfma_f32_32x32x16_bf16 v[0:15], v[160:163], v[168:171], v[0:15]
    ds_read_b128 v[192:195], v237 offset:0
    ds_read_b128 v[196:199], v237 offset:4096
    v_mfma_f32_32x32x16_bf16 v[16:31], v[164:167], v[168:171], v[16:31]
    ds_read_b64_tr_b16 v[200:201], v240 offset:18432
    ds_read_b64_tr_b16 v[202:203], v240 offset:18944
    v_mfma_f32_32x32x16_bf16 v[32:47], v[160:163], v[172:175], v[32:47]
    ds_read_b64_tr_b16 v[204:205], v240 offset:26624
    v_mfma_f32_32x32x16_bf16 v[48:63], v[164:167], v[172:175], v[48:63]
    ds_read_b64_tr_b16 v[206:207], v240 offset:27136
    s_waitcnt lgkmcnt(6)
    v_mfma_f32_32x32x16_bf16 v[0:15], v[176:179], v[184:187], v[0:15]
    ds_read_b128 v[160:163], v238 offset:0
    ds_read_b128 v[164:167], v238 offset:4096
    v_mfma_f32_32x32x16_bf16 v[16:31], v[180:183], v[184:187], v[16:31]
    ds_read_b64_tr_b16 v[168:169], v240 offset:20480
    ds_read_b64_tr_b16 v[170:171], v240 offset:20992
    v_mfma_f32_32x32x16_bf16 v[32:47], v[176:179], v[188:191], v[32:47]
    ds_read_b64_tr_b16 v[172:173], v240 offset:28672
    v_mfma_f32_32x32x16_bf16 v[48:63], v[180:183], v[188:191], v[48:63]
    ds_read_b64_tr_b16 v[174:175], v240 offset:29184
    s_waitcnt lgkmcnt(6)
    v_mfma_f32_32x32x16_bf16 v[0:15], v[192:195], v[200:203], v[0:15]
    ds_read_b128 v[176:179], v239 offset:0
    ds_read_b128 v[180:183], v239 offset:4096
    v_mfma_f32_32x32x16_bf16 v[16:31], v[196:199], v[200:203], v[16:31]
    ds_read_b64_tr_b16 v[184:185], v240 offset:22528
    ds_read_b64_tr_b16 v[186:187], v240 offset:23040
    v_mfma_f32_32x32x16_bf16 v[32:47], v[192:195], v[204:207], v[32:47]
    ds_read_b64_tr_b16 v[188:189], v240 offset:30720
    v_mfma_f32_32x32x16_bf16 v[48:63], v[196:199], v[204:207], v[48:63]
    ds_read_b64_tr_b16 v[190:191], v240 offset:31232
    s_waitcnt lgkmcnt(6)
    v_mfma_f32_32x32x16_bf16 v[0:15], v[160:163], v[168:171], v[0:15]
    v_mfma_f32_32x32x16_bf16 v[16:31], v[164:167], v[168:171], v[16:31]
    s_waitcnt lgkmcnt(0)
    s_barrier
    ds_read_b128 v[192:195], v236 offset:16384
    v_mfma_f32_32x32x16_bf16 v[32:47], v[160:163], v[172:175], v[32:47]
    ds_read_b128 v[196:199], v236 offset:20480
    ds_read_b64_tr_b16 v[200:201], v240 offset:32768
    ds_read_b64_tr_b16 v[202:203], v240 offset:33280
    v_mfma_f32_32x32x16_bf16 v[48:63], v[164:167], v[172:175], v[48:63]
    ds_read_b64_tr_b16 v[204:205], v240 offset:40960
    ds_read_b64_tr_b16 v[206:207], v240 offset:41472
    v_mfma_f32_32x32x16_bf16 v[0:15], v[176:179], v[184:187], v[0:15]
    ds_read_b128 v[160:163], v237 offset:16384
    ds_read_b128 v[164:167], v237 offset:20480
    v_mfma_f32_32x32x16_bf16 v[16:31], v[180:183], v[184:187], v[16:31]
    ds_read_b64_tr_b16 v[168:169], v240 offset:34816
    ds_read_b64_tr_b16 v[170:171], v240 offset:35328
    v_mfma_f32_32x32x16_bf16 v[32:47], v[176:179], v[188:191], v[32:47]
    ds_read_b64_tr_b16 v[172:173], v240 offset:43008
    v_mfma_f32_32x32x16_bf16 v[48:63], v[180:183], v[188:191], v[48:63]
    ds_read_b64_tr_b16 v[174:175], v240 offset:43520
    s_waitcnt lgkmcnt(6)
    v_mfma_f32_32x32x16_bf16 v[0:15], v[192:195], v[200:203], v[0:15]
    ds_read_b128 v[176:179], v238 offset:16384
    ds_read_b128 v[180:183], v238 offset:20480
    v_mfma_f32_32x32x16_bf16 v[16:31], v[196:199], v[200:203], v[16:31]
    ds_read_b64_tr_b16 v[184:185], v240 offset:36864
    ds_read_b64_tr_b16 v[186:187], v240 offset:37376
    v_mfma_f32_32x32x16_bf16 v[32:47], v[192:195], v[204:207], v[32:47]
    ds_read_b64_tr_b16 v[188:189], v240 offset:45056
    v_mfma_f32_32x32x16_bf16 v[48:63], v[196:199], v[204:207], v[48:63]
    ds_read_b64_tr_b16 v[190:191], v240 offset:45568
    s_waitcnt lgkmcnt(6)
    v_mfma_f32_32x32x16_bf16 v[0:15], v[160:163], v[168:171], v[0:15]
    ds_read_b128 v[192:195], v239 offset:16384
    ds_read_b128 v[196:199], v239 offset:20480
    v_mfma_f32_32x32x16_bf16 v[16:31], v[164:167], v[168:171], v[16:31]
    ds_read_b64_tr_b16 v[200:201], v240 offset:38912
    ds_read_b64_tr_b16 v[202:203], v240 offset:39424
    v_mfma_f32_32x32x16_bf16 v[32:47], v[160:163], v[172:175], v[32:47]
    ds_read_b64_tr_b16 v[204:205], v240 offset:47104
    v_mfma_f32_32x32x16_bf16 v[48:63], v[164:167], v[172:175], v[48:63]
    ds_read_b64_tr_b16 v[206:207], v240 offset:47616
    s_waitcnt lgkmcnt(6)
    v_mfma_f32_32x32x16_bf16 v[0:15], v[176:179], v[184:187], v[0:15]
    v_mfma_f32_32x32x16_bf16 v[16:31], v[180:183], v[184:187], v[16:31]
    s_waitcnt lgkmcnt(0)
    s_barrier
    ds_read_b128 v[160:163], v236 offset:32768
    v_mfma_f32_32x32x16_bf16 v[32:47], v[176:179], v[188:191], v[32:47]
    ds_read_b128 v[164:167], v236 offset:36864
    ds_read_b64_tr_b16 v[168:169], v240 offset:0
    ds_read_b64_tr_b16 v[170:171], v240 offset:512
    v_mfma_f32_32x32x16_bf16 v[48:63], v[180:183], v[188:191], v[48:63]
    ds_read_b64_tr_b16 v[172:173], v240 offset:8192
    ds_read_b64_tr_b16 v[174:175], v240 offset:8704
    v_mfma_f32_32x32x16_bf16 v[0:15], v[192:195], v[200:203], v[0:15]
    ds_read_b128 v[176:179], v237 offset:32768
    ds_read_b128 v[180:183], v237 offset:36864
    v_mfma_f32_32x32x16_bf16 v[16:31], v[196:199], v[200:203], v[16:31]
    ds_read_b64_tr_b16 v[184:185], v240 offset:2048
    ds_read_b64_tr_b16 v[186:187], v240 offset:2560
    v_mfma_f32_32x32x16_bf16 v[32:47], v[192:195], v[204:207], v[32:47]
    ds_read_b64_tr_b16 v[188:189], v240 offset:10240
    v_mfma_f32_32x32x16_bf16 v[48:63], v[196:199], v[204:207], v[48:63]
    ds_read_b64_tr_b16 v[190:191], v240 offset:10752
    s_waitcnt lgkmcnt(6)
    v_mfma_f32_32x32x16_bf16 v[0:15], v[160:163], v[168:171], v[0:15]
    ds_read_b128 v[192:195], v238 offset:32768
    ds_read_b128 v[196:199], v238 offset:36864
    v_mfma_f32_32x32x16_bf16 v[16:31], v[164:167], v[168:171], v[16:31]
    ds_read_b64_tr_b16 v[200:201], v240 offset:4096
    ds_read_b64_tr_b16 v[202:203], v240 offset:4608
    v_mfma_f32_32x32x16_bf16 v[32:47], v[160:163], v[172:175], v[32:47]
    ds_read_b64_tr_b16 v[204:205], v240 offset:12288
    s_mov_b32 s55, 0x20000
    s_mov_b32 s54, 1605632
    s_and_b32 s32, s28, 1
    s_cmp_eq_u32 s32, 0
    s_cselect_b32 s52, s80, s82
    s_cselect_b32 s53, s81, s83
    s_and_b32 s33, s25, 7
    s_lshl_b32 s33, s33, 1
    s_lshr_b32 s31, s28, 1
    s_add_u32 s33, s33, s31
    v_min_u32 v250, 27, v253
    s_mul_i32 s33, s33, 100352
    s_lshl_b32 s32, s26, 7
    s_add_u32 s32, s32, 1536
    v_mul_u32_u24 v252, 3584, v250
    s_add_u32 s33, s33, s32
    buffer_load_dword v244, v252, s[52:55], s33 offen offset:0
    v_mfma_f32_32x32x16_bf16 v[48:63], v[164:167], v[172:175], v[48:63]
    ds_read_b64_tr_b16 v[206:207], v240 offset:12800
    s_waitcnt lgkmcnt(6)
    v_mfma_f32_32x32x16_bf16 v[0:15], v[176:179], v[184:187], v[0:15]
    ds_read_b128 v[160:163], v239 offset:32768
    ds_read_b128 v[164:167], v239 offset:36864
    v_mfma_f32_32x32x16_bf16 v[16:31], v[180:183], v[184:187], v[16:31]
    ds_read_b64_tr_b16 v[168:169], v240 offset:6144
    ds_read_b64_tr_b16 v[170:171], v240 offset:6656
    v_mfma_f32_32x32x16_bf16 v[32:47], v[176:179], v[188:191], v[32:47]
    ds_read_b64_tr_b16 v[172:173], v240 offset:14336
    v_mfma_f32_32x32x16_bf16 v[48:63], v[180:183], v[188:191], v[48:63]
    ds_read_b64_tr_b16 v[174:175], v240 offset:14848
    s_waitcnt lgkmcnt(6)
    v_mfma_f32_32x32x16_bf16 v[0:15], v[192:195], v[200:203], v[0:15]
    ds_read_b128 v[176:179], v232 offset:0
    ds_read_b128 v[180:183], v232 offset:4096
    v_mfma_f32_32x32x16_bf16 v[16:31], v[196:199], v[200:203], v[16:31]
    v_mfma_f32_32x32x16_bf16 v[32:47], v[192:195], v[204:207], v[32:47]
    s_waitcnt lgkmcnt(2)
    s_barrier
    ds_read_b64_tr_b16 v[184:185], v240 offset:16384
    ds_read_b64_tr_b16 v[186:187], v240 offset:16896
    v_mfma_f32_32x32x16_bf16 v[48:63], v[196:199], v[204:207], v[48:63]
    v_mfma_f32_32x32x16_bf16 v[0:15], v[160:163], v[168:171], v[0:15]
    ds_read_b128 v[192:195], v233 offset:0
    v_mfma_f32_32x32x16_bf16 v[16:31], v[164:167], v[168:171], v[16:31]
    ds_read_b128 v[196:199], v233 offset:4096
    v_mfma_f32_32x32x16_bf16 v[32:47], v[160:163], v[172:175], v[32:47]
    ds_read_b64_tr_b16 v[200:201], v240 offset:18432
    v_mfma_f32_32x32x16_bf16 v[48:63], v[164:167], v[172:175], v[48:63]
    ds_read_b64_tr_b16 v[202:203], v240 offset:18944
    s_waitcnt lgkmcnt(4)
    v_mfma_f32_32x32x16_bf16 v[128:143], v[184:187], v[176:179], 0
    ds_read_b128 v[160:163], v234 offset:0
    ds_read_b128 v[164:167], v234 offset:4096
    v_mfma_f32_32x32x16_bf16 v[144:159], v[184:187], v[180:183], 0
    ds_read_b64_tr_b16 v[168:169], v240 offset:20480
    ds_read_b64_tr_b16 v[170:171], v240 offset:20992
    v_cvt_pk_bf16_f32 v0, v0, v1
    v_cvt_pk_bf16_f32 v1, v2, v3
    v_cvt_pk_bf16_f32 v2, v4, v5
    s_waitcnt lgkmcnt(4)
    v_mfma_f32_32x32x16_bf16 v[128:143], v[200:203], v[192:195], v[128:143]
    ds_read_b128 v[176:179], v235 offset:0
    ds_read_b128 v[180:183], v235 offset:4096
    v_cvt_pk_bf16_f32 v3, v6, v7
    v_cndmask_b32 v0, v0, v242, s[40:41]
    v_cndmask_b32 v1, v1, v242, s[40:41]
    v_cndmask_b32 v2, v2, v242, s[40:41]
    v_mfma_f32_32x32x16_bf16 v[144:159], v[200:203], v[196:199], v[144:159]
    ds_read_b64_tr_b16 v[184:185], v240 offset:22528
    ds_read_b64_tr_b16 v[186:187], v240 offset:23040
    v_cndmask_b32 v3, v3, v242, s[40:41]
    v_cvt_pk_bf16_f32 v4, v8, v9
    v_cvt_pk_bf16_f32 v5, v10, v11
    s_waitcnt lgkmcnt(4)
    v_mfma_f32_32x32x16_bf16 v[128:143], v[168:171], v[160:163], v[128:143]
    ds_read_b128 v[192:195], v232 offset:16384
    ds_read_b128 v[196:199], v232 offset:20480
    s_add_u32 s33, s48, 0
    buffer_store_dwordx4 v[0:3], v254, s[20:23], s33 offen offset:0 sc1
    v_cvt_pk_bf16_f32 v6, v12, v13
    v_cvt_pk_bf16_f32 v7, v14, v15
    v_mfma_f32_32x32x16_bf16 v[144:159], v[168:171], v[164:167], v[144:159]
    ds_read_b64_tr_b16 v[200:201], v240 offset:24576
    ds_read_b64_tr_b16 v[202:203], v240 offset:25088
    v_cndmask_b32 v4, v4, v242, s[40:41]
    v_cndmask_b32 v5, v5, v242, s[40:41]
    v_cndmask_b32 v6, v6, v242, s[40:41]
    s_waitcnt lgkmcnt(4)
    v_mfma_f32_32x32x16_bf16 v[128:143], v[184:187], v[176:179], v[128:143]
    ds_read_b128 v[160:163], v233 offset:16384
    ds_read_b128 v[164:167], v233 offset:20480
    v_cndmask_b32 v7, v7, v242, s[40:41]
    v_cvt_pk_bf16_f32 v16, v16, v17
    v_cvt_pk_bf16_f32 v17, v18, v19
    v_cvt_pk_bf16_f32 v18, v20, v21
    v_mfma_f32_32x32x16_bf16 v[144:159], v[184:187], v[180:183], v[144:159]
    ds_read_b64_tr_b16 v[168:169], v240 offset:26624
    ds_read_b64_tr_b16 v[170:171], v240 offset:27136
    s_add_u32 s33, s48, 0
    buffer_store_dwordx4 v[4:7], v254, s[20:23], s33 offen offset:1024 sc1
    v_cvt_pk_bf16_f32 v19, v22, v23
    s_waitcnt lgkmcnt(4)
    v_mfma_f32_32x32x16_bf16 v[128:143], v[200:203], v[192:195], v[128:143]
    ds_read_b128 v[176:179], v234 offset:16384
    ds_read_b128 v[180:183], v234 offset:20480
    v_cndmask_b32 v16, v16, v242, s[40:41]
    v_cndmask_b32 v17, v17, v242, s[40:41]
    v_cndmask_b32 v18, v18, v242, s[40:41]
    v_cndmask_b32 v19, v19, v242, s[40:41]
    v_mfma_f32_32x32x16_bf16 v[144:159], v[200:203], v[196:199], v[144:159]
    ds_read_b64_tr_b16 v[184:185], v240 offset:28672
    ds_read_b64_tr_b16 v[186:187], v240 offset:29184
    s_add_u32 s33, s48, 4096
    buffer_store_dwordx4 v[16:19], v254, s[20:23], s33 offen offset:0 sc1
    v_cvt_pk_bf16_f32 v20, v24, v25
    s_waitcnt lgkmcnt(4)
    v_mfma_f32_32x32x16_bf16 v[128:143], v[168:171], v[160:163], v[128:143]
    ds_read_b128 v[192:195], v235 offset:16384
    ds_read_b128 v[196:199], v235 offset:20480
    v_cvt_pk_bf16_f32 v21, v26, v27
    v_cvt_pk_bf16_f32 v22, v28, v29
    v_cvt_pk_bf16_f32 v23, v30, v31
    v_cndmask_b32 v20, v20, v242, s[40:41]
    v_mfma_f32_32x32x16_bf16 v[144:159], v[168:171], v[164:167], v[144:159]
    ds_read_b64_tr_b16 v[200:201], v240 offset:30720
    ds_read_b64_tr_b16 v[202:203], v240 offset:31232
    v_cndmask_b32 v21, v21, v242, s[40:41]
    v_cndmask_b32 v22, v22, v242, s[40:41]
    v_cndmask_b32 v23, v23, v242, s[40:41]
    s_waitcnt lgkmcnt(4)
    v_mfma_f32_32x32x16_bf16 v[128:143], v[184:187], v[176:179], v[128:143]
    ds_read_b128 v[160:163], v232 offset:32768
    ds_read_b128 v[164:167], v232 offset:36864
    v_cvt_pk_bf16_f32 v32, v32, v33
    v_cvt_pk_bf16_f32 v33, v34, v35
    v_cvt_pk_bf16_f32 v34, v36, v37
    v_cvt_pk_bf16_f32 v35, v38, v39
    v_mfma_f32_32x32x16_bf16 v[144:159], v[184:187], v[180:183], v[144:159]
    s_waitcnt lgkmcnt(2)
    s_barrier
    ds_read_b64_tr_b16 v[168:169], v240 offset:32768
    ds_read_b64_tr_b16 v[170:171], v240 offset:33280
    v_cndmask_b32 v32, v32, v242, s[40:41]
    v_cndmask_b32 v33, v33, v242, s[40:41]
    v_mfma_f32_32x32x16_bf16 v[128:143], v[200:203], v[192:195], v[128:143]
    ds_read_b128 v[176:179], v233 offset:32768
    ds_read_b128 v[180:183], v233 offset:36864
    v_cndmask_b32 v34, v34, v242, s[40:41]
    v_cndmask_b32 v35, v35, v242, s[40:41]
    v_cvt_pk_bf16_f32 v36, v40, v41
    v_cvt_pk_bf16_f32 v37, v42, v43
    v_mfma_f32_32x32x16_bf16 v[144:159], v[200:203], v[196:199], v[144:159]
    ds_read_b64_tr_b16 v[184:185], v240 offset:34816
    ds_read_b64_tr_b16 v[186:187], v240 offset:35328
    v_cvt_pk_bf16_f32 v38, v44, v45
    v_cvt_pk_bf16_f32 v39, v46, v47
    v_cndmask_b32 v36, v36, v242, s[40:41]
    s_waitcnt lgkmcnt(4)
    v_mfma_f32_32x32x16_bf16 v[128:143], v[168:171], v[160:163], v[128:143]
    ds_read_b128 v[192:195], v234 offset:32768
    ds_read_b128 v[196:199], v234 offset:36864
    v_cndmask_b32 v37, v37, v242, s[40:41]
    v_cndmask_b32 v38, v38, v242, s[40:41]
    v_cndmask_b32 v39, v39, v242, s[40:41]
    v_cvt_pk_bf16_f32 v48, v48, v49
    v_mfma_f32_32x32x16_bf16 v[144:159], v[168:171], v[164:167], v[144:159]
    ds_read_b64_tr_b16 v[200:201], v240 offset:36864
    ds_read_b64_tr_b16 v[202:203], v240 offset:37376
    v_cvt_pk_bf16_f32 v49, v50, v51
    v_cvt_pk_bf16_f32 v50, v52, v53
    v_cvt_pk_bf16_f32 v51, v54, v55
    s_waitcnt lgkmcnt(4)
    v_mfma_f32_32x32x16_bf16 v[128:143], v[184:187], v[176:179], v[128:143]
    ds_read_b128 v[160:163], v235 offset:32768
    ds_read_b128 v[164:167], v235 offset:36864
    v_cndmask_b32 v48, v48, v242, s[40:41]
    v_cndmask_b32 v49, v49, v242, s[40:41]
    v_cndmask_b32 v50, v50, v242, s[40:41]
    v_cndmask_b32 v51, v51, v242, s[40:41]
    v_mfma_f32_32x32x16_bf16 v[144:159], v[184:187], v[180:183], v[144:159]
    ds_read_b64_tr_b16 v[168:169], v240 offset:38912
    ds_read_b64_tr_b16 v[170:171], v240 offset:39424
    v_cvt_pk_bf16_f32 v52, v56, v57
    v_cvt_pk_bf16_f32 v53, v58, v59
    v_cvt_pk_bf16_f32 v54, v60, v61
    s_waitcnt lgkmcnt(4)
    v_mfma_f32_32x32x16_bf16 v[128:143], v[200:203], v[192:195], v[128:143]
    ds_read_b128 v[176:179], v232 offset:49152
    ds_read_b128 v[180:183], v232 offset:53248
    s_add_u32 s33, s48, 4096
    buffer_store_dwordx4 v[20:23], v254, s[20:23], s33 offen offset:1024 sc1
    v_cvt_pk_bf16_f32 v55, v62, v63
    v_cndmask_b32 v52, v52, v242, s[40:41]
    v_mfma_f32_32x32x16_bf16 v[144:159], v[200:203], v[196:199], v[144:159]
    ds_read_b64_tr_b16 v[184:185], v240 offset:40960
    ds_read_b64_tr_b16 v[186:187], v240 offset:41472
    s_add_u32 s33, s48, 524288
    buffer_store_dwordx4 v[32:35], v254, s[20:23], s33 offen offset:0 sc1
    v_cndmask_b32 v53, v53, v242, s[40:41]
    s_waitcnt lgkmcnt(4)
    v_mfma_f32_32x32x16_bf16 v[128:143], v[168:171], v[160:163], v[128:143]
    ds_read_b128 v[192:195], v233 offset:49152
    ds_read_b128 v[196:199], v233 offset:53248
    s_add_u32 s33, s48, 524288
    buffer_store_dwordx4 v[36:39], v254, s[20:23], s33 offen offset:1024 sc1
    v_cndmask_b32 v54, v54, v242, s[40:41]
    v_cndmask_b32 v55, v55, v242, s[40:41]
    v_mfma_f32_32x32x16_bf16 v[144:159], v[168:171], v[164:167], v[144:159]
    ds_read_b64_tr_b16 v[200:201], v240 offset:43008
    ds_read_b64_tr_b16 v[202:203], v240 offset:43520
    s_add_u32 s33, s48, 528384
    buffer_store_dwordx4 v[48:51], v254, s[20:23], s33 offen offset:0 sc1
    s_waitcnt lgkmcnt(4)
    v_mfma_f32_32x32x16_bf16 v[128:143], v[184:187], v[176:179], v[128:143]
    ds_read_b128 v[160:163], v234 offset:49152
    ds_read_b128 v[164:167], v234 offset:53248
    s_add_u32 s33, s48, 528384
    buffer_store_dwordx4 v[52:55], v254, s[20:23], s33 offen offset:1024 sc1
    v_mfma_f32_32x32x16_bf16 v[144:159], v[184:187], v[180:183], v[144:159]
    ds_read_b64_tr_b16 v[168:169], v240 offset:45056
    ds_read_b64_tr_b16 v[170:171], v240 offset:45568
    s_waitcnt lgkmcnt(4)
    v_mfma_f32_32x32x16_bf16 v[128:143], v[200:203], v[192:195], v[128:143]
    ds_read_b128 v[176:179], v235 offset:49152
    ds_read_b128 v[180:183], v235 offset:53248
    v_mfma_f32_32x32x16_bf16 v[144:159], v[200:203], v[196:199], v[144:159]
    ds_read_b64_tr_b16 v[184:185], v240 offset:47104
    ds_read_b64_tr_b16 v[186:187], v240 offset:47616
    s_waitcnt lgkmcnt(4)
    v_mfma_f32_32x32x16_bf16 v[128:143], v[168:171], v[160:163], v[128:143]
    ds_read_b128 v[192:195], v236 offset:0
    ds_read_b128 v[196:199], v236 offset:4096
    v_mfma_f32_32x32x16_bf16 v[144:159], v[168:171], v[164:167], v[144:159]
    s_waitcnt lgkmcnt(2)
    s_barrier
    ds_read_b64_tr_b16 v[200:201], v240 offset:0
    ds_read_b64_tr_b16 v[202:203], v240 offset:512
    v_mfma_f32_32x32x16_bf16 v[128:143], v[184:187], v[176:179], v[128:143]
    ds_read_b128 v[160:163], v237 offset:0
    ds_read_b128 v[164:167], v237 offset:4096
    v_mfma_f32_32x32x16_bf16 v[144:159], v[184:187], v[180:183], v[144:159]
    ds_read_b64_tr_b16 v[168:169], v240 offset:2048
    ds_read_b64_tr_b16 v[170:171], v240 offset:2560
    s_waitcnt lgkmcnt(4)
    v_mfma_f32_32x32x16_bf16 v[128:143], v[200:203], v[192:195], v[128:143]
    ds_read_b128 v[176:179], v238 offset:0
    ds_read_b128 v[180:183], v238 offset:4096
    v_mfma_f32_32x32x16_bf16 v[144:159], v[200:203], v[196:199], v[144:159]
    ds_read_b64_tr_b16 v[184:185], v240 offset:4096
    ds_read_b64_tr_b16 v[186:187], v240 offset:4608
    s_waitcnt lgkmcnt(4)
    v_mfma_f32_32x32x16_bf16 v[128:143], v[168:171], v[160:163], v[128:143]
    ds_read_b128 v[192:195], v239 offset:0
    ds_read_b128 v[196:199], v239 offset:4096
    v_mfma_f32_32x32x16_bf16 v[144:159], v[168:171], v[164:167], v[144:159]
    ds_read_b64_tr_b16 v[200:201], v240 offset:6144
    ds_read_b64_tr_b16 v[202:203], v240 offset:6656
    s_waitcnt lgkmcnt(4)
    v_mfma_f32_32x32x16_bf16 v[128:143], v[184:187], v[176:179], v[128:143]
    ds_read_b128 v[160:163], v236 offset:16384
    ds_read_b128 v[164:167], v236 offset:20480
    s_mov_b32 s55, 0x20000
    s_mov_b32 s54, 1605632
    s_mov_b32 s52, s84
    s_mov_b32 s53, s85
    s_mul_i32 s32, s2, 6272
    s_mul_i32 s33, s28, 1664
    s_add_u32 s33, s32, s33
    v_min_u32 v250, 12, v253
    v_lshlrev_b32 v252, 7, v250
    buffer_load_dword v245, v252, s[52:55], s33 offen offset:0
    v_mfma_f32_32x32x16_bf16 v[144:159], v[184:187], v[180:183], v[144:159]
    ds_read_b64_tr_b16 v[168:169], v240 offset:8192
    ds_read_b64_tr_b16 v[170:171], v240 offset:8704
    s_waitcnt lgkmcnt(4)
    v_mfma_f32_32x32x16_bf16 v[128:143], v[200:203], v[192:195], v[128:143]
    ds_read_b128 v[176:179], v237 offset:16384
    ds_read_b128 v[180:183], v237 offset:20480
    v_mfma_f32_32x32x16_bf16 v[144:159], v[200:203], v[196:199], v[144:159]
    ds_read_b64_tr_b16 v[184:185], v240 offset:10240
    ds_read_b64_tr_b16 v[186:187], v240 offset:10752
    s_waitcnt lgkmcnt(4)
    v_mfma_f32_32x32x16_bf16 v[128:143], v[168:171], v[160:163], v[128:143]
    ds_read_b128 v[192:195], v238 offset:16384
    ds_read_b128 v[196:199], v238 offset:20480
    v_mfma_f32_32x32x16_bf16 v[144:159], v[168:171], v[164:167], v[144:159]
    ds_read_b64_tr_b16 v[200:201], v240 offset:12288
    ds_read_b64_tr_b16 v[202:203], v240 offset:12800
    s_waitcnt lgkmcnt(4)
    v_mfma_f32_32x32x16_bf16 v[128:143], v[184:187], v[176:179], v[128:143]
    ds_read_b128 v[160:163], v239 offset:16384
    ds_read_b128 v[164:167], v239 offset:20480
    v_mfma_f32_32x32x16_bf16 v[144:159], v[184:187], v[180:183], v[144:159]
    ds_read_b64_tr_b16 v[168:169], v240 offset:14336
    ds_read_b64_tr_b16 v[170:171], v240 offset:14848
    s_waitcnt lgkmcnt(4)
    v_mfma_f32_32x32x16_bf16 v[128:143], v[200:203], v[192:195], v[128:143]
    ds_read_b128 v[176:179], v236 offset:32768
    ds_read_b128 v[180:183], v236 offset:36864
    v_mfma_f32_32x32x16_bf16 v[144:159], v[200:203], v[196:199], v[144:159]
    s_waitcnt lgkmcnt(2)
    s_barrier
    ds_read_b64_tr_b16 v[184:185], v240 offset:16384
    ds_read_b64_tr_b16 v[186:187], v240 offset:16896
    v_mfma_f32_32x32x16_bf16 v[128:143], v[168:171], v[160:163], v[128:143]
    ds_read_b128 v[192:195], v237 offset:32768
    ds_read_b128 v[196:199], v237 offset:36864
    v_mfma_f32_32x32x16_bf16 v[144:159], v[168:171], v[164:167], v[144:159]
    ds_read_b64_tr_b16 v[200:201], v240 offset:18432
    ds_read_b64_tr_b16 v[202:203], v240 offset:18944
    s_waitcnt lgkmcnt(4)
    v_mfma_f32_32x32x16_bf16 v[128:143], v[184:187], v[176:179], v[128:143]
    ds_read_b128 v[160:163], v238 offset:32768
    ds_read_b128 v[164:167], v238 offset:36864
    v_mfma_f32_32x32x16_bf16 v[144:159], v[184:187], v[180:183], v[144:159]
    ds_read_b64_tr_b16 v[168:169], v240 offset:20480
    ds_read_b64_tr_b16 v[170:171], v240 offset:20992
    s_waitcnt lgkmcnt(4)
    v_mfma_f32_32x32x16_bf16 v[128:143], v[200:203], v[192:195], v[128:143]
    ds_read_b128 v[176:179], v239 offset:32768
    ds_read_b128 v[180:183], v239 offset:36864
    v_mfma_f32_32x32x16_bf16 v[144:159], v[200:203], v[196:199], v[144:159]
    ds_read_b64_tr_b16 v[184:185], v240 offset:22528
    ds_read_b64_tr_b16 v[186:187], v240 offset:23040
    s_waitcnt lgkmcnt(4)
    v_mfma_f32_32x32x16_bf16 v[128:143], v[168:171], v[160:163], v[128:143]
    ds_read_b128 v[192:195], v232 offset:0
    ds_read_b128 v[196:199], v232 offset:4096
    v_mfma_f32_32x32x16_bf16 v[144:159], v[168:171], v[164:167], v[144:159]
    s_waitcnt lgkmcnt(2)
    s_barrier
    ds_read_b64_tr_b16 v[200:201], v240 offset:32768
    ds_read_b64_tr_b16 v[202:203], v240 offset:33280
    ds_read_b64_tr_b16 v[204:205], v240 offset:40960
    ds_read_b64_tr_b16 v[206:207], v240 offset:41472
    v_mfma_f32_32x32x16_bf16 v[128:143], v[184:187], v[176:179], v[128:143]
    ds_read_b128 v[160:163], v233 offset:0
    ds_read_b128 v[164:167], v233 offset:4096
    ds_read_b64_tr_b16 v[168:169], v240 offset:34816
    v_mfma_f32_32x32x16_bf16 v[144:159], v[184:187], v[180:183], v[144:159]
    ds_read_b64_tr_b16 v[170:171], v240 offset:35328
    ds_read_b64_tr_b16 v[172:173], v240 offset:43008
    ds_read_b64_tr_b16 v[174:175], v240 offset:43520
    s_waitcnt lgkmcnt(6)
    v_mfma_f32_32x32x16_bf16 v[64:79], v[200:203], v[192:195], 0
    ds_read_b128 v[176:179], v234 offset:0
    ds_read_b128 v[180:183], v234 offset:4096
    v_mfma_f32_32x32x16_bf16 v[80:95], v[200:203], v[196:199], 0
    ds_read_b64_tr_b16 v[184:185], v240 offset:36864
    ds_read_b64_tr_b16 v[186:187], v240 offset:37376
    v_mul_f32 v140, v241, v140
    v_mul_f32 v141, v241, v141
    v_mul_f32 v142, v241, v142
    v_mul_f32 v143, v241, v143
    v_mfma_f32_32x32x16_bf16 v[96:111], v[204:207], v[192:195], 0
    ds_read_b64_tr_b16 v[188:189], v240 offset:45056
    v_cvt_pk_bf16_f32 v128, v128, v129
    v_cvt_pk_bf16_f32 v129, v130, v131
    v_cvt_pk_bf16_f32 v130, v132, v133
    v_cvt_pk_bf16_f32 v131, v134, v135
    v_mfma_f32_32x32x16_bf16 v[112:127], v[204:207], v[196:199], 0
    ds_read_b64_tr_b16 v[190:191], v240 offset:45568
    buffer_store_dwordx4 v[128:131], v254, s[20:23], s36 offen offset:0 sc1
    v_cvt_pk_bf16_f32 v132, v136, v137
    v_cvt_pk_bf16_f32 v133, v138, v139
    s_waitcnt lgkmcnt(6)
    v_mfma_f32_32x32x16_bf16 v[64:79], v[168:171], v[160:163], v[64:79]
    ds_read_b128 v[192:195], v235 offset:0
    ds_read_b128 v[196:199], v235 offset:4096
    v_cvt_pk_bf16_f32 v134, v140, v141
    v_cvt_pk_bf16_f32 v135, v142, v143
    v_mul_f32 v156, v241, v156
    v_mul_f32 v157, v241, v157
    v_mfma_f32_32x32x16_bf16 v[80:95], v[168:171], v[164:167], v[80:95]
    ds_read_b64_tr_b16 v[200:201], v240 offset:38912
    ds_read_b64_tr_b16 v[202:203], v240 offset:39424
    buffer_store_dwordx4 v[132:135], v254, s[20:23], s36 offen offset:1024 sc1
    v_mul_f32 v158, v241, v158
    v_mul_f32 v159, v241, v159
    v_mfma_f32_32x32x16_bf16 v[96:111], v[172:175], v[160:163], v[96:111]
    ds_read_b64_tr_b16 v[204:205], v240 offset:47104
    v_cvt_pk_bf16_f32 v144, v144, v145
    v_cvt_pk_bf16_f32 v145, v146, v147
    v_cvt_pk_bf16_f32 v146, v148, v149
    v_cvt_pk_bf16_f32 v147, v150, v151
    v_mfma_f32_32x32x16_bf16 v[112:127], v[172:175], v[164:167], v[112:127]
    ds_read_b64_tr_b16 v[206:207], v240 offset:47616
    s_add_u32 s36, s36, s37
    buffer_store_dwordx4 v[144:147], v254, s[20:23], s36 offen offset:0 sc1
    v_cvt_pk_bf16_f32 v148, v152, v153
    v_cvt_pk_bf16_f32 v149, v154, v155
    s_waitcnt lgkmcnt(6)
    v_mfma_f32_32x32x16_bf16 v[64:79], v[184:187], v[176:179], v[64:79]
    ds_read_b128 v[160:163], v232 offset:16384
    ds_read_b128 v[164:167], v232 offset:20480
    v_cvt_pk_bf16_f32 v150, v156, v157
    v_cvt_pk_bf16_f32 v151, v158, v159
    v_mfma_f32_32x32x16_bf16 v[80:95], v[184:187], v[180:183], v[80:95]
    buffer_store_dwordx4 v[148:151], v254, s[20:23], s36 offen offset:1024 sc1
    v_mfma_f32_32x32x16_bf16 v[96:111], v[188:191], v[176:179], v[96:111]
    s_waitcnt lgkmcnt(2)
    s_barrier
    ds_read_b64_tr_b16 v[168:169], v240 offset:0
    ds_read_b64_tr_b16 v[170:171], v240 offset:512
    v_mfma_f32_32x32x16_bf16 v[112:127], v[188:191], v[180:183], v[112:127]
    ds_read_b64_tr_b16 v[172:173], v240 offset:8192
    ds_read_b64_tr_b16 v[174:175], v240 offset:8704
    v_mfma_f32_32x32x16_bf16 v[64:79], v[200:203], v[192:195], v[64:79]
    ds_read_b128 v[176:179], v233 offset:16384
    ds_read_b128 v[180:183], v233 offset:20480
    v_mfma_f32_32x32x16_bf16 v[80:95], v[200:203], v[196:199], v[80:95]
    ds_read_b64_tr_b16 v[184:185], v240 offset:2048
    ds_read_b64_tr_b16 v[186:187], v240 offset:2560
    v_mfma_f32_32x32x16_bf16 v[96:111], v[204:207], v[192:195], v[96:111]
    ds_read_b64_tr_b16 v[188:189], v240 offset:10240
    v_mfma_f32_32x32x16_bf16 v[112:127], v[204:207], v[196:199], v[112:127]
    ds_read_b64_tr_b16 v[190:191], v240 offset:10752
    s_waitcnt lgkmcnt(6)
    v_mfma_f32_32x32x16_bf16 v[64:79], v[168:171], v[160:163], v[64:79]
    ds_read_b128 v[192:195], v234 offset:16384
    ds_read_b128 v[196:199], v234 offset:20480
    v_mfma_f32_32x32x16_bf16 v[80:95], v[168:171], v[164:167], v[80:95]
    ds_read_b64_tr_b16 v[200:201], v240 offset:4096
    ds_read_b64_tr_b16 v[202:203], v240 offset:4608
    v_mfma_f32_32x32x16_bf16 v[96:111], v[172:175], v[160:163], v[96:111]
    ds_read_b64_tr_b16 v[204:205], v240 offset:12288
    v_mfma_f32_32x32x16_bf16 v[112:127], v[172:175], v[164:167], v[112:127]
    ds_read_b64_tr_b16 v[206:207], v240 offset:12800
    s_waitcnt lgkmcnt(6)
    v_mfma_f32_32x32x16_bf16 v[64:79], v[184:187], v[176:179], v[64:79]
    ds_read_b128 v[160:163], v235 offset:16384
    ds_read_b128 v[164:167], v235 offset:20480
    v_mfma_f32_32x32x16_bf16 v[80:95], v[184:187], v[180:183], v[80:95]
    ds_read_b64_tr_b16 v[168:169], v240 offset:6144
    ds_read_b64_tr_b16 v[170:171], v240 offset:6656
    v_mfma_f32_32x32x16_bf16 v[96:111], v[188:191], v[176:179], v[96:111]
    ds_read_b64_tr_b16 v[172:173], v240 offset:14336
    v_mfma_f32_32x32x16_bf16 v[112:127], v[188:191], v[180:183], v[112:127]
    ds_read_b64_tr_b16 v[174:175], v240 offset:14848
    s_waitcnt lgkmcnt(6)
    v_mfma_f32_32x32x16_bf16 v[64:79], v[200:203], v[192:195], v[64:79]
    ds_read_b128 v[176:179], v232 offset:32768
    ds_read_b128 v[180:183], v232 offset:36864
    v_mfma_f32_32x32x16_bf16 v[80:95], v[200:203], v[196:199], v[80:95]
    v_mfma_f32_32x32x16_bf16 v[96:111], v[204:207], v[192:195], v[96:111]
    s_waitcnt lgkmcnt(2)
    s_waitcnt vmcnt(0)
    s_barrier
    ds_read_b64_tr_b16 v[184:185], v240 offset:16384
    ds_read_b64_tr_b16 v[186:187], v240 offset:16896
    v_mfma_f32_32x32x16_bf16 v[112:127], v[204:207], v[196:199], v[112:127]
    ds_read_b64_tr_b16 v[188:189], v240 offset:24576
    ds_read_b64_tr_b16 v[190:191], v240 offset:25088
    v_mfma_f32_32x32x16_bf16 v[64:79], v[168:171], v[160:163], v[64:79]
    ds_read_b128 v[192:195], v233 offset:32768
    ds_read_b128 v[196:199], v233 offset:36864
    v_mfma_f32_32x32x16_bf16 v[80:95], v[168:171], v[164:167], v[80:95]
    ds_read_b64_tr_b16 v[200:201], v240 offset:18432
    ds_read_b64_tr_b16 v[202:203], v240 offset:18944
    v_mfma_f32_32x32x16_bf16 v[96:111], v[172:175], v[160:163], v[96:111]
    ds_read_b64_tr_b16 v[204:205], v240 offset:26624
    v_mfma_f32_32x32x16_bf16 v[112:127], v[172:175], v[164:167], v[112:127]
    ds_read_b64_tr_b16 v[206:207], v240 offset:27136
    s_waitcnt lgkmcnt(6)
    v_mfma_f32_32x32x16_bf16 v[64:79], v[184:187], v[176:179], v[64:79]
    ds_read_b128 v[160:163], v234 offset:32768
    ds_read_b128 v[164:167], v234 offset:36864
    v_mfma_f32_32x32x16_bf16 v[80:95], v[184:187], v[180:183], v[80:95]
    ds_read_b64_tr_b16 v[168:169], v240 offset:20480
    ds_read_b64_tr_b16 v[170:171], v240 offset:20992
    v_mfma_f32_32x32x16_bf16 v[96:111], v[188:191], v[176:179], v[96:111]
    ds_read_b64_tr_b16 v[172:173], v240 offset:28672
    v_mfma_f32_32x32x16_bf16 v[112:127], v[188:191], v[180:183], v[112:127]
    ds_read_b64_tr_b16 v[174:175], v240 offset:29184
    s_waitcnt lgkmcnt(6)
    v_mfma_f32_32x32x16_bf16 v[64:79], v[200:203], v[192:195], v[64:79]
    ds_read_b128 v[176:179], v235 offset:32768
    ds_read_b128 v[180:183], v235 offset:36864
    v_mfma_f32_32x32x16_bf16 v[80:95], v[200:203], v[196:199], v[80:95]
    ds_read_b64_tr_b16 v[184:185], v240 offset:22528
    ds_read_b64_tr_b16 v[186:187], v240 offset:23040
    v_mfma_f32_32x32x16_bf16 v[96:111], v[204:207], v[192:195], v[96:111]
    ds_read_b64_tr_b16 v[188:189], v240 offset:30720
    v_mfma_f32_32x32x16_bf16 v[112:127], v[204:207], v[196:199], v[112:127]
    ds_read_b64_tr_b16 v[190:191], v240 offset:31232
    s_waitcnt lgkmcnt(6)
    v_mfma_f32_32x32x16_bf16 v[64:79], v[168:171], v[160:163], v[64:79]
    ds_read_b128 v[192:195], v232 offset:49152
    ds_read_b128 v[196:199], v232 offset:53248
    v_mfma_f32_32x32x16_bf16 v[80:95], v[168:171], v[164:167], v[80:95]
    v_mfma_f32_32x32x16_bf16 v[96:111], v[172:175], v[160:163], v[96:111]
    s_waitcnt lgkmcnt(2)
    s_barrier
    ds_read_b64_tr_b16 v[200:201], v240 offset:32768
    ds_read_b64_tr_b16 v[202:203], v240 offset:33280
    v_mfma_f32_32x32x16_bf16 v[112:127], v[172:175], v[164:167], v[112:127]
    ds_read_b64_tr_b16 v[204:205], v240 offset:40960
    ds_read_b64_tr_b16 v[206:207], v240 offset:41472
    v_mfma_f32_32x32x16_bf16 v[64:79], v[184:187], v[176:179], v[64:79]
    ds_read_b128 v[160:163], v233 offset:49152
    ds_read_b128 v[164:167], v233 offset:53248
    v_mfma_f32_32x32x16_bf16 v[80:95], v[184:187], v[180:183], v[80:95]
    ds_read_b64_tr_b16 v[168:169], v240 offset:34816
    ds_read_b64_tr_b16 v[170:171], v240 offset:35328
    v_mfma_f32_32x32x16_bf16 v[96:111], v[188:191], v[176:179], v[96:111]
    ds_read_b64_tr_b16 v[172:173], v240 offset:43008
    v_mfma_f32_32x32x16_bf16 v[112:127], v[188:191], v[180:183], v[112:127]
    ds_read_b64_tr_b16 v[174:175], v240 offset:43520
    s_waitcnt lgkmcnt(6)
    v_mfma_f32_32x32x16_bf16 v[64:79], v[200:203], v[192:195], v[64:79]
    ds_read_b128 v[176:179], v234 offset:49152
    ds_read_b128 v[180:183], v234 offset:53248
    v_mfma_f32_32x32x16_bf16 v[80:95], v[200:203], v[196:199], v[80:95]
    ds_read_b64_tr_b16 v[184:185], v240 offset:36864
    ds_read_b64_tr_b16 v[186:187], v240 offset:37376
    v_mfma_f32_32x32x16_bf16 v[96:111], v[204:207], v[192:195], v[96:111]
    ds_read_b64_tr_b16 v[188:189], v240 offset:45056
    v_mfma_f32_32x32x16_bf16 v[112:127], v[204:207], v[196:199], v[112:127]
    ds_read_b64_tr_b16 v[190:191], v240 offset:45568
    s_waitcnt lgkmcnt(6)
    v_mfma_f32_32x32x16_bf16 v[64:79], v[168:171], v[160:163], v[64:79]
    ds_read_b128 v[192:195], v235 offset:49152
    ds_read_b128 v[196:199], v235 offset:53248
    v_mfma_f32_32x32x16_bf16 v[80:95], v[168:171], v[164:167], v[80:95]
    ds_read_b64_tr_b16 v[200:201], v240 offset:38912
    ds_read_b64_tr_b16 v[202:203], v240 offset:39424
    v_mfma_f32_32x32x16_bf16 v[96:111], v[172:175], v[160:163], v[96:111]
    ds_read_b64_tr_b16 v[204:205], v240 offset:47104
    v_mfma_f32_32x32x16_bf16 v[112:127], v[172:175], v[164:167], v[112:127]
    ds_read_b64_tr_b16 v[206:207], v240 offset:47616
    s_waitcnt lgkmcnt(6)
    v_mfma_f32_32x32x16_bf16 v[64:79], v[184:187], v[176:179], v[64:79]
    ds_read_b128 v[160:163], v236 offset:0
    ds_read_b128 v[164:167], v236 offset:4096
    v_mfma_f32_32x32x16_bf16 v[80:95], v[184:187], v[180:183], v[80:95]
    v_mfma_f32_32x32x16_bf16 v[96:111], v[188:191], v[176:179], v[96:111]
    s_waitcnt lgkmcnt(2)
    s_barrier
    ds_read_b64_tr_b16 v[168:169], v240 offset:0
    ds_read_b64_tr_b16 v[170:171], v240 offset:512
    v_mfma_f32_32x32x16_bf16 v[112:127], v[188:191], v[180:183], v[112:127]
    ds_read_b64_tr_b16 v[172:173], v240 offset:8192
    ds_read_b64_tr_b16 v[174:175], v240 offset:8704
    v_mfma_f32_32x32x16_bf16 v[64:79], v[200:203], v[192:195], v[64:79]
    ds_read_b128 v[176:179], v237 offset:0
    ds_read_b128 v[180:183], v237 offset:4096
    v_mfma_f32_32x32x16_bf16 v[80:95], v[200:203], v[196:199], v[80:95]
    ds_read_b64_tr_b16 v[184:185], v240 offset:2048
    ds_read_b64_tr_b16 v[186:187], v240 offset:2560
    v_mfma_f32_32x32x16_bf16 v[96:111], v[204:207], v[192:195], v[96:111]
    ds_read_b64_tr_b16 v[188:189], v240 offset:10240
    v_mfma_f32_32x32x16_bf16 v[112:127], v[204:207], v[196:199], v[112:127]
    ds_read_b64_tr_b16 v[190:191], v240 offset:10752
    s_waitcnt lgkmcnt(6)
    v_mfma_f32_32x32x16_bf16 v[64:79], v[168:171], v[160:163], v[64:79]
    ds_read_b128 v[192:195], v238 offset:0
    ds_read_b128 v[196:199], v238 offset:4096
    v_mfma_f32_32x32x16_bf16 v[80:95], v[168:171], v[164:167], v[80:95]
    ds_read_b64_tr_b16 v[200:201], v240 offset:4096
    ds_read_b64_tr_b16 v[202:203], v240 offset:4608
    v_mfma_f32_32x32x16_bf16 v[96:111], v[172:175], v[160:163], v[96:111]
    ds_read_b64_tr_b16 v[204:205], v240 offset:12288
    v_mfma_f32_32x32x16_bf16 v[112:127], v[172:175], v[164:167], v[112:127]
    ds_read_b64_tr_b16 v[206:207], v240 offset:12800
    s_waitcnt lgkmcnt(6)
    v_mfma_f32_32x32x16_bf16 v[64:79], v[184:187], v[176:179], v[64:79]
    ds_read_b128 v[160:163], v239 offset:0
    ds_read_b128 v[164:167], v239 offset:4096
    v_mfma_f32_32x32x16_bf16 v[80:95], v[184:187], v[180:183], v[80:95]
    ds_read_b64_tr_b16 v[168:169], v240 offset:6144
    ds_read_b64_tr_b16 v[170:171], v240 offset:6656
    v_mfma_f32_32x32x16_bf16 v[96:111], v[188:191], v[176:179], v[96:111]
    ds_read_b64_tr_b16 v[172:173], v240 offset:14336
    v_mfma_f32_32x32x16_bf16 v[112:127], v[188:191], v[180:183], v[112:127]
    ds_read_b64_tr_b16 v[174:175], v240 offset:14848
    s_waitcnt lgkmcnt(6)
    v_mfma_f32_32x32x16_bf16 v[64:79], v[200:203], v[192:195], v[64:79]
    ds_read_b128 v[176:179], v236 offset:16384
    ds_read_b128 v[180:183], v236 offset:20480
    v_mfma_f32_32x32x16_bf16 v[80:95], v[200:203], v[196:199], v[80:95]
    v_mfma_f32_32x32x16_bf16 v[96:111], v[204:207], v[192:195], v[96:111]
    s_waitcnt lgkmcnt(2)
    s_barrier
    ds_read_b64_tr_b16 v[184:185], v240 offset:16384
    ds_read_b64_tr_b16 v[186:187], v240 offset:16896
    v_mfma_f32_32x32x16_bf16 v[112:127], v[204:207], v[196:199], v[112:127]
    ds_read_b64_tr_b16 v[188:189], v240 offset:24576
    ds_read_b64_tr_b16 v[190:191], v240 offset:25088
    v_mfma_f32_32x32x16_bf16 v[64:79], v[168:171], v[160:163], v[64:79]
    ds_read_b128 v[192:195], v237 offset:16384
    ds_read_b128 v[196:199], v237 offset:20480
    v_mfma_f32_32x32x16_bf16 v[80:95], v[168:171], v[164:167], v[80:95]
    ds_read_b64_tr_b16 v[200:201], v240 offset:18432
    ds_read_b64_tr_b16 v[202:203], v240 offset:18944
    v_mfma_f32_32x32x16_bf16 v[96:111], v[172:175], v[160:163], v[96:111]
    ds_read_b64_tr_b16 v[204:205], v240 offset:26624
    v_mfma_f32_32x32x16_bf16 v[112:127], v[172:175], v[164:167], v[112:127]
    ds_read_b64_tr_b16 v[206:207], v240 offset:27136
    s_waitcnt lgkmcnt(6)
    v_mfma_f32_32x32x16_bf16 v[64:79], v[184:187], v[176:179], v[64:79]
    ds_read_b128 v[160:163], v238 offset:16384
    ds_read_b128 v[164:167], v238 offset:20480
    v_mfma_f32_32x32x16_bf16 v[80:95], v[184:187], v[180:183], v[80:95]
    ds_read_b64_tr_b16 v[168:169], v240 offset:20480
    ds_read_b64_tr_b16 v[170:171], v240 offset:20992
    v_mfma_f32_32x32x16_bf16 v[96:111], v[188:191], v[176:179], v[96:111]
    ds_read_b64_tr_b16 v[172:173], v240 offset:28672
    v_mfma_f32_32x32x16_bf16 v[112:127], v[188:191], v[180:183], v[112:127]
    ds_read_b64_tr_b16 v[174:175], v240 offset:29184
    s_waitcnt lgkmcnt(6)
    v_mfma_f32_32x32x16_bf16 v[64:79], v[200:203], v[192:195], v[64:79]
    ds_read_b128 v[176:179], v239 offset:16384
    ds_read_b128 v[180:183], v239 offset:20480
    v_mfma_f32_32x32x16_bf16 v[80:95], v[200:203], v[196:199], v[80:95]
    ds_read_b64_tr_b16 v[184:185], v240 offset:22528
    ds_read_b64_tr_b16 v[186:187], v240 offset:23040
    v_mfma_f32_32x32x16_bf16 v[96:111], v[204:207], v[192:195], v[96:111]
    ds_read_b64_tr_b16 v[188:189], v240 offset:30720
    v_mfma_f32_32x32x16_bf16 v[112:127], v[204:207], v[196:199], v[112:127]
    ds_read_b64_tr_b16 v[190:191], v240 offset:31232
    s_waitcnt lgkmcnt(6)
    v_mfma_f32_32x32x16_bf16 v[64:79], v[168:171], v[160:163], v[64:79]
    ds_read_b128 v[192:195], v236 offset:32768
    ds_read_b128 v[196:199], v236 offset:36864
    v_mfma_f32_32x32x16_bf16 v[80:95], v[168:171], v[164:167], v[80:95]
    v_mfma_f32_32x32x16_bf16 v[96:111], v[172:175], v[160:163], v[96:111]
    s_waitcnt lgkmcnt(2)
    s_waitcnt vmcnt(0)
    s_barrier
    ds_read_b64_tr_b16 v[200:201], v240 offset:32768
    ds_read_b64_tr_b16 v[202:203], v240 offset:33280
    v_mfma_f32_32x32x16_bf16 v[112:127], v[172:175], v[164:167], v[112:127]
    ds_read_b64_tr_b16 v[204:205], v240 offset:40960
    ds_read_b64_tr_b16 v[206:207], v240 offset:41472
    v_mfma_f32_32x32x16_bf16 v[64:79], v[184:187], v[176:179], v[64:79]
    ds_read_b128 v[160:163], v237 offset:32768
    ds_read_b128 v[164:167], v237 offset:36864
    v_mfma_f32_32x32x16_bf16 v[80:95], v[184:187], v[180:183], v[80:95]
    ds_read_b64_tr_b16 v[168:169], v240 offset:34816
    ds_read_b64_tr_b16 v[170:171], v240 offset:35328
    v_mfma_f32_32x32x16_bf16 v[96:111], v[188:191], v[176:179], v[96:111]
    ds_read_b64_tr_b16 v[172:173], v240 offset:43008
    v_mfma_f32_32x32x16_bf16 v[112:127], v[188:191], v[180:183], v[112:127]
    ds_read_b64_tr_b16 v[174:175], v240 offset:43520
    s_waitcnt lgkmcnt(6)
    v_mfma_f32_32x32x16_bf16 v[64:79], v[200:203], v[192:195], v[64:79]
    ds_read_b128 v[176:179], v238 offset:32768
    ds_read_b128 v[180:183], v238 offset:36864
    v_mfma_f32_32x32x16_bf16 v[80:95], v[200:203], v[196:199], v[80:95]
    ds_read_b64_tr_b16 v[184:185], v240 offset:36864
    ds_read_b64_tr_b16 v[186:187], v240 offset:37376
    v_mfma_f32_32x32x16_bf16 v[96:111], v[204:207], v[192:195], v[96:111]
    ds_read_b64_tr_b16 v[188:189], v240 offset:45056
    v_mfma_f32_32x32x16_bf16 v[112:127], v[204:207], v[196:199], v[112:127]
    ds_read_b64_tr_b16 v[190:191], v240 offset:45568
    s_waitcnt lgkmcnt(6)
    v_mfma_f32_32x32x16_bf16 v[64:79], v[168:171], v[160:163], v[64:79]
    ds_read_b128 v[192:195], v239 offset:32768
    ds_read_b128 v[196:199], v239 offset:36864
    v_mfma_f32_32x32x16_bf16 v[80:95], v[168:171], v[164:167], v[80:95]
    ds_read_b64_tr_b16 v[200:201], v240 offset:38912
    ds_read_b64_tr_b16 v[202:203], v240 offset:39424
    v_mfma_f32_32x32x16_bf16 v[96:111], v[172:175], v[160:163], v[96:111]
    ds_read_b64_tr_b16 v[204:205], v240 offset:47104
    v_mfma_f32_32x32x16_bf16 v[112:127], v[172:175], v[164:167], v[112:127]
    ds_read_b64_tr_b16 v[206:207], v240 offset:47616
    s_waitcnt lgkmcnt(6)
    v_mfma_f32_32x32x16_bf16 v[64:79], v[184:187], v[176:179], v[64:79]
    v_mfma_f32_32x32x16_bf16 v[80:95], v[184:187], v[180:183], v[80:95]
    v_mfma_f32_32x32x16_bf16 v[96:111], v[188:191], v[176:179], v[96:111]
    v_mfma_f32_32x32x16_bf16 v[112:127], v[188:191], v[180:183], v[112:127]
    s_waitcnt lgkmcnt(0)
    v_mfma_f32_32x32x16_bf16 v[64:79], v[200:203], v[192:195], v[64:79]
    v_mfma_f32_32x32x16_bf16 v[80:95], v[200:203], v[196:199], v[80:95]
    v_mfma_f32_32x32x16_bf16 v[96:111], v[204:207], v[192:195], v[96:111]
    v_mfma_f32_32x32x16_bf16 v[112:127], v[204:207], v[196:199], v[112:127]
    v_mov_b32 v228, s39
    v_mov_b32 v229, s39
    v_mov_b32 v230, 1.0
    v_mov_b32 v231, 1.0
    s_nop 4
    v_pk_mul_f32 v[220:221], v[64:65], v[228:229]
    v_pk_mul_f32 v[222:223], v[66:67], v[228:229]
    v_pk_mul_f32 v[224:225], v[68:69], v[228:229]
    v_pk_mul_f32 v[226:227], v[70:71], v[228:229]
    v_exp_f32 v220, v220
    v_exp_f32 v221, v221
    v_pk_mul_f32 v[64:65], v[64:65], v[96:97]
    v_exp_f32 v222, v222
    v_exp_f32 v223, v223
    v_pk_mul_f32 v[66:67], v[66:67], v[98:99]
    v_exp_f32 v224, v224
    v_exp_f32 v225, v225
    v_pk_mul_f32 v[68:69], v[68:69], v[100:101]
    v_exp_f32 v226, v226
    v_exp_f32 v227, v227
    v_pk_mul_f32 v[70:71], v[70:71], v[102:103]
    v_pk_add_f32 v[220:221], v[220:221], v[230:231]
    v_pk_add_f32 v[222:223], v[222:223], v[230:231]
    v_pk_add_f32 v[224:225], v[224:225], v[230:231]
    v_pk_add_f32 v[226:227], v[226:227], v[230:231]
    v_rcp_f32 v220, v220
    v_rcp_f32 v221, v221
    v_rcp_f32 v222, v222
    v_rcp_f32 v223, v223
    v_rcp_f32 v224, v224
    v_rcp_f32 v225, v225
    v_rcp_f32 v226, v226
    v_rcp_f32 v227, v227
    v_pk_mul_f32 v[64:65], v[64:65], v[220:221]
    v_pk_mul_f32 v[66:67], v[66:67], v[222:223]
    v_pk_mul_f32 v[68:69], v[68:69], v[224:225]
    v_pk_mul_f32 v[70:71], v[70:71], v[226:227]
    v_cvt_pk_bf16_f32 v96, v64, v65
    v_cvt_pk_bf16_f32 v97, v66, v67
    v_cvt_pk_bf16_f32 v98, v68, v69
    v_cvt_pk_bf16_f32 v99, v70, v71
    s_add_u32 s33, s35, 49152
    buffer_store_dwordx4 v[96:99], v254, s[20:23], s33 offen offset:0 sc1
    v_pk_mul_f32 v[220:221], v[72:73], v[228:229]
    v_pk_mul_f32 v[222:223], v[74:75], v[228:229]
    v_pk_mul_f32 v[224:225], v[76:77], v[228:229]
    v_pk_mul_f32 v[226:227], v[78:79], v[228:229]
    v_exp_f32 v220, v220
    v_exp_f32 v221, v221
    v_pk_mul_f32 v[72:73], v[72:73], v[104:105]
    v_exp_f32 v222, v222
    v_exp_f32 v223, v223
    v_pk_mul_f32 v[74:75], v[74:75], v[106:107]
    v_exp_f32 v224, v224
    v_exp_f32 v225, v225
    v_pk_mul_f32 v[76:77], v[76:77], v[108:109]
    v_exp_f32 v226, v226
    v_exp_f32 v227, v227
    v_pk_mul_f32 v[78:79], v[78:79], v[110:111]
    v_pk_add_f32 v[220:221], v[220:221], v[230:231]
    v_pk_add_f32 v[222:223], v[222:223], v[230:231]
    v_pk_add_f32 v[224:225], v[224:225], v[230:231]
    v_pk_add_f32 v[226:227], v[226:227], v[230:231]
    v_rcp_f32 v220, v220
    v_rcp_f32 v221, v221
    v_rcp_f32 v222, v222
    v_rcp_f32 v223, v223
    v_rcp_f32 v224, v224
    v_rcp_f32 v225, v225
    v_rcp_f32 v226, v226
    v_rcp_f32 v227, v227
    v_pk_mul_f32 v[72:73], v[72:73], v[220:221]
    v_pk_mul_f32 v[74:75], v[74:75], v[222:223]
    v_pk_mul_f32 v[76:77], v[76:77], v[224:225]
    v_pk_mul_f32 v[78:79], v[78:79], v[226:227]
    v_cvt_pk_bf16_f32 v100, v72, v73
    v_cvt_pk_bf16_f32 v101, v74, v75
    v_cvt_pk_bf16_f32 v102, v76, v77
    v_cvt_pk_bf16_f32 v103, v78, v79
    s_add_u32 s33, s35, 49152
    buffer_store_dwordx4 v[100:103], v254, s[20:23], s33 offen offset:1024 sc1
    v_pk_mul_f32 v[220:221], v[80:81], v[228:229]
    v_pk_mul_f32 v[222:223], v[82:83], v[228:229]
    v_pk_mul_f32 v[224:225], v[84:85], v[228:229]
    v_pk_mul_f32 v[226:227], v[86:87], v[228:229]
    v_exp_f32 v220, v220
    v_exp_f32 v221, v221
    v_pk_mul_f32 v[80:81], v[80:81], v[112:113]
    v_exp_f32 v222, v222
    v_exp_f32 v223, v223
    v_pk_mul_f32 v[82:83], v[82:83], v[114:115]
    v_exp_f32 v224, v224
    v_exp_f32 v225, v225
    v_pk_mul_f32 v[84:85], v[84:85], v[116:117]
    v_exp_f32 v226, v226
    v_exp_f32 v227, v227
    v_pk_mul_f32 v[86:87], v[86:87], v[118:119]
    v_pk_add_f32 v[220:221], v[220:221], v[230:231]
    v_pk_add_f32 v[222:223], v[222:223], v[230:231]
    v_pk_add_f32 v[224:225], v[224:225], v[230:231]
    v_pk_add_f32 v[226:227], v[226:227], v[230:231]
    v_rcp_f32 v220, v220
    v_rcp_f32 v221, v221
    v_rcp_f32 v222, v222
    v_rcp_f32 v223, v223
    v_rcp_f32 v224, v224
    v_rcp_f32 v225, v225
    v_rcp_f32 v226, v226
    v_rcp_f32 v227, v227
    v_pk_mul_f32 v[80:81], v[80:81], v[220:221]
    v_pk_mul_f32 v[82:83], v[82:83], v[222:223]
    v_pk_mul_f32 v[84:85], v[84:85], v[224:225]
    v_pk_mul_f32 v[86:87], v[86:87], v[226:227]
    v_cvt_pk_bf16_f32 v112, v80, v81
    v_cvt_pk_bf16_f32 v113, v82, v83
    v_cvt_pk_bf16_f32 v114, v84, v85
    v_cvt_pk_bf16_f32 v115, v86, v87
    s_add_u32 s33, s35, 163840
    buffer_store_dwordx4 v[112:115], v254, s[20:23], s33 offen offset:0 sc1
    v_pk_mul_f32 v[220:221], v[88:89], v[228:229]
    v_pk_mul_f32 v[222:223], v[90:91], v[228:229]
    v_pk_mul_f32 v[224:225], v[92:93], v[228:229]
    v_pk_mul_f32 v[226:227], v[94:95], v[228:229]
    v_exp_f32 v220, v220
    v_exp_f32 v221, v221
    v_pk_mul_f32 v[88:89], v[88:89], v[120:121]
    v_exp_f32 v222, v222
    v_exp_f32 v223, v223
    v_pk_mul_f32 v[90:91], v[90:91], v[122:123]
    v_exp_f32 v224, v224
    v_exp_f32 v225, v225
    v_pk_mul_f32 v[92:93], v[92:93], v[124:125]
    v_exp_f32 v226, v226
    v_exp_f32 v227, v227
    v_pk_mul_f32 v[94:95], v[94:95], v[126:127]
    v_pk_add_f32 v[220:221], v[220:221], v[230:231]
    v_pk_add_f32 v[222:223], v[222:223], v[230:231]
    v_pk_add_f32 v[224:225], v[224:225], v[230:231]
    v_pk_add_f32 v[226:227], v[226:227], v[230:231]
    v_rcp_f32 v220, v220
    v_rcp_f32 v221, v221
    v_rcp_f32 v222, v222
    v_rcp_f32 v223, v223
    v_rcp_f32 v224, v224
    v_rcp_f32 v225, v225
    v_rcp_f32 v226, v226
    v_rcp_f32 v227, v227
    v_pk_mul_f32 v[88:89], v[88:89], v[220:221]
    v_pk_mul_f32 v[90:91], v[90:91], v[222:223]
    v_pk_mul_f32 v[92:93], v[92:93], v[224:225]
    v_pk_mul_f32 v[94:95], v[94:95], v[226:227]
    v_cvt_pk_bf16_f32 v116, v88, v89
    v_cvt_pk_bf16_f32 v117, v90, v91
    v_cvt_pk_bf16_f32 v118, v92, v93
    v_cvt_pk_bf16_f32 v119, v94, v95
    s_add_u32 s33, s35, 163840
    buffer_store_dwordx4 v[116:119], v254, s[20:23], s33 offen offset:1024 sc1
L_k12_attn:
    s_nop 1
    s_and_b32 s29, s28, 1
    s_lshr_b32 s30, s28, 1
    s_lshr_b32 s32, s69, 4
    s_lshl_b32 s34, s68, 1
    s_add_u32 s34, s34, s32
    s_and_b32 s35, s69, 15
    s_lshl_b32 s37, s34, 18
    s_add_u32 s37, s37, 2097152
    s_lshl_b32 s33, s35, 2
    s_lshl_b32 s32, s29, 1
    s_add_u32 s33, s33, s32
    s_add_u32 s33, s33, s30
    s_lshl_b32 s36, s33, 4
    s_add_u32 s36, s36, s34
    s_lshl_b32 s36, s36, 11
    s_add_u32 s36, s36, 16777216
    s_lshl_b32 s31, s30, 13
    v_add_u32 v1, s31, v254
    s_lshl_b32 s31, s29, 12
    s_add_u32 s31, s31, 73728
    v_add_u32 v3, s31, v254
    s_lshl_b32 s31, s29, 13
    s_add_u32 s31, s31, 147456
    v_add_u32 v2, s31, v254
    v_mov_b32 v160, 0
    v_mov_b32 v176, 0
    v_mov_b32 v161, 0
    v_mov_b32 v177, 0
    v_mov_b32 v162, 0
    v_mov_b32 v178, 0
    v_mov_b32 v163, 0
    v_mov_b32 v179, 0
    v_mov_b32 v164, 0
    v_mov_b32 v180, 0
    v_mov_b32 v165, 0
    v_mov_b32 v181, 0
    v_mov_b32 v166, 0
    v_mov_b32 v182, 0
    v_mov_b32 v167, 0
    v_mov_b32 v183, 0
    v_mov_b32 v168, 0
    v_mov_b32 v184, 0
    v_mov_b32 v169, 0
    v_mov_b32 v185, 0
    v_mov_b32 v170, 0
    v_mov_b32 v186, 0
    v_mov_b32 v171, 0
    v_mov_b32 v187, 0
    v_mov_b32 v172, 0
    v_mov_b32 v188, 0
    v_mov_b32 v173, 0
    v_mov_b32 v189, 0
    v_mov_b32 v174, 0
    v_mov_b32 v190, 0
    v_mov_b32 v175, 0
    v_mov_b32 v191, 0
    v_mov_b32 v56, 0
    v_mov_b32 v60, 0
    v_mov_b32 v40, 0
    v_mov_b32 v44, 0
    v_mov_b32 v57, 0
    v_mov_b32 v61, 0
    v_mov_b32 v41, 0
    v_mov_b32 v45, 0
    v_mov_b32 v58, 0
    v_mov_b32 v62, 0
    v_mov_b32 v42, 0
    v_mov_b32 v46, 0
    v_mov_b32 v59, 0
    v_mov_b32 v63, 0
    v_mov_b32 v43, 0
    v_mov_b32 v47, 0
    s_mov_b32 s38, 0
    s_barrier
    ds_read_b128 v[8:11], v3 offset:0
    ds_read_b128 v[12:15], v3 offset:1024
    ds_read_b128 v[16:19], v3 offset:2048
    ds_read_b128 v[20:23], v3 offset:3072
    ds_read_b128 v[24:27], v1 offset:0
    ds_read_b128 v[28:31], v1 offset:1024
    ds_read_b128 v[36:39], v1 offset:3072
    ds_read_b128 v[32:35], v1 offset:2048
    s_waitcnt lgkmcnt(3)
    v_mfma_f32_32x32x16_bf16 v[128:143], v[24:27], v[8:11], 0
    s_waitcnt lgkmcnt(2)
    v_mfma_f32_32x32x16_bf16 v[128:143], v[28:31], v[12:15], v[128:143]
    s_waitcnt lgkmcnt(0)
    s_nop 10
L_k12_aloop:
    v_mfma_f32_32x32x16_bf16 v[144:159], v[24:27], v[16:19], 0
    v_exp_f32 v128, v128
    v_exp_f32 v129, v129
    v_exp_f32 v130, v130
    v_mfma_f32_32x32x16_bf16 v[144:159], v[28:31], v[20:23], v[144:159]
    ds_read_b128 v[24:27], v1 offset:4096
    v_exp_f32 v131, v131
    v_exp_f32 v132, v132
    v_cvt_pk_bf16_f32 v48, v128, v129
    v_mfma_f32_32x32x16_bf16 v[176:191], v[40:43], v[56:59], v[176:191]
    ds_read_b128 v[28:31], v1 offset:5120
    v_exp_f32 v133, v133
    v_exp_f32 v134, v134
    v_cvt_pk_bf16_f32 v49, v130, v131
    v_mfma_f32_32x32x16_bf16 v[176:191], v[44:47], v[60:63], v[176:191]
    v_exp_f32 v135, v135
    v_exp_f32 v136, v136
    v_exp_f32 v137, v137
    v_exp_f32 v138, v138
    v_exp_f32 v139, v139
    v_exp_f32 v140, v140
    v_exp_f32 v141, v141
    v_exp_f32 v142, v142
    v_exp_f32 v143, v143
    v_cvt_pk_bf16_f32 v50, v132, v133
    v_cvt_pk_bf16_f32 v51, v134, v135
    v_cvt_pk_bf16_f32 v52, v136, v137
    v_cvt_pk_bf16_f32 v53, v138, v139
    v_cvt_pk_bf16_f32 v54, v140, v141
    v_cvt_pk_bf16_f32 v55, v142, v143
    s_waitcnt lgkmcnt(1)
    v_mfma_f32_32x32x16_bf16 v[128:143], v[24:27], v[8:11], 0
    v_exp_f32 v144, v144
    v_exp_f32 v145, v145
    v_exp_f32 v146, v146
    s_waitcnt lgkmcnt(0)
    v_mfma_f32_32x32x16_bf16 v[128:143], v[28:31], v[12:15], v[128:143]
    ds_read_b128 v[44:47], v1 offset:7168
    v_exp_f32 v147, v147
    v_exp_f32 v148, v148
    v_cvt_pk_bf16_f32 v56, v144, v145
    v_mfma_f32_32x32x16_bf16 v[160:175], v[32:35], v[48:51], v[160:175]
    ds_read_b128 v[40:43], v1 offset:6144
    v_exp_f32 v149, v149
    v_exp_f32 v150, v150
    v_cvt_pk_bf16_f32 v57, v146, v147
    v_mfma_f32_32x32x16_bf16 v[160:175], v[36:39], v[52:55], v[160:175]
    v_exp_f32 v151, v151
    v_exp_f32 v152, v152
    v_exp_f32 v153, v153
    v_exp_f32 v154, v154
    v_exp_f32 v155, v155
    v_exp_f32 v156, v156
    v_exp_f32 v157, v157
    v_exp_f32 v158, v158
    v_exp_f32 v159, v159
    v_cvt_pk_bf16_f32 v58, v148, v149
    v_cvt_pk_bf16_f32 v59, v150, v151
    v_cvt_pk_bf16_f32 v60, v152, v153
    v_cvt_pk_bf16_f32 v61, v154, v155
    v_cvt_pk_bf16_f32 v62, v156, v157
    v_cvt_pk_bf16_f32 v63, v158, v159
    v_mfma_f32_32x32x16_bf16 v[144:159], v[24:27], v[16:19], 0
    v_exp_f32 v128, v128
    v_exp_f32 v129, v129
    v_exp_f32 v130, v130
    v_mfma_f32_32x32x16_bf16 v[144:159], v[28:31], v[20:23], v[144:159]
    ds_read_b128 v[24:27], v1 offset:16384
    v_exp_f32 v131, v131
    v_exp_f32 v132, v132
    v_cvt_pk_bf16_f32 v48, v128, v129
    v_mfma_f32_32x32x16_bf16 v[176:191], v[32:35], v[56:59], v[176:191]
    ds_read_b128 v[28:31], v1 offset:17408
    v_exp_f32 v133, v133
    v_exp_f32 v134, v134
    v_cvt_pk_bf16_f32 v49, v130, v131
    v_mfma_f32_32x32x16_bf16 v[176:191], v[36:39], v[60:63], v[176:191]
    v_exp_f32 v135, v135
    v_exp_f32 v136, v136
    v_exp_f32 v137, v137
    v_exp_f32 v138, v138
    v_exp_f32 v139, v139
    v_exp_f32 v140, v140
    v_exp_f32 v141, v141
    v_exp_f32 v142, v142
    v_exp_f32 v143, v143
    v_cvt_pk_bf16_f32 v50, v132, v133
    v_cvt_pk_bf16_f32 v51, v134, v135
    v_cvt_pk_bf16_f32 v52, v136, v137
    v_cvt_pk_bf16_f32 v53, v138, v139
    v_cvt_pk_bf16_f32 v54, v140, v141
    v_cvt_pk_bf16_f32 v55, v142, v143
    s_waitcnt lgkmcnt(1)
    v_mfma_f32_32x32x16_bf16 v[128:143], v[24:27], v[8:11], 0
    v_exp_f32 v144, v144
    v_exp_f32 v145, v145
    v_exp_f32 v146, v146
    s_waitcnt lgkmcnt(0)
    v_mfma_f32_32x32x16_bf16 v[128:143], v[28:31], v[12:15], v[128:143]
    ds_read_b128 v[36:39], v1 offset:19456
    v_exp_f32 v147, v147
    v_exp_f32 v148, v148
    v_cvt_pk_bf16_f32 v56, v144, v145
    v_mfma_f32_32x32x16_bf16 v[160:175], v[40:43], v[48:51], v[160:175]
    ds_read_b128 v[32:35], v1 offset:18432
    v_exp_f32 v149, v149
    v_exp_f32 v150, v150
    v_cvt_pk_bf16_f32 v57, v146, v147
    v_mfma_f32_32x32x16_bf16 v[160:175], v[44:47], v[52:55], v[160:175]
    v_exp_f32 v151, v151
    v_exp_f32 v152, v152
    v_exp_f32 v153, v153
    v_exp_f32 v154, v154
    v_exp_f32 v155, v155
    v_exp_f32 v156, v156
    v_exp_f32 v157, v157
    v_exp_f32 v158, v158
    v_exp_f32 v159, v159
    v_cvt_pk_bf16_f32 v58, v148, v149
    v_cvt_pk_bf16_f32 v59, v150, v151
    v_cvt_pk_bf16_f32 v60, v152, v153
    v_cvt_pk_bf16_f32 v61, v154, v155
    v_cvt_pk_bf16_f32 v62, v156, v157
    v_cvt_pk_bf16_f32 v63, v158, v159
    s_barrier
    v_mfma_f32_32x32x16_bf16 v[144:159], v[24:27], v[16:19], 0
    v_exp_f32 v128, v128
    v_exp_f32 v129, v129
    v_exp_f32 v130, v130
    v_mfma_f32_32x32x16_bf16 v[144:159], v[28:31], v[20:23], v[144:159]
    ds_read_b128 v[24:27], v1 offset:20480
    v_exp_f32 v131, v131
    v_exp_f32 v132, v132
    v_cvt_pk_bf16_f32 v48, v128, v129
    v_mfma_f32_32x32x16_bf16 v[176:191], v[40:43], v[56:59], v[176:191]
    ds_read_b128 v[28:31], v1 offset:21504
    v_exp_f32 v133, v133
    v_exp_f32 v134, v134
    v_cvt_pk_bf16_f32 v49, v130, v131
    v_mfma_f32_32x32x16_bf16 v[176:191], v[44:47], v[60:63], v[176:191]
    v_exp_f32 v135, v135
    v_exp_f32 v136, v136
    v_exp_f32 v137, v137
    v_exp_f32 v138, v138
    v_exp_f32 v139, v139
    v_exp_f32 v140, v140
    v_exp_f32 v141, v141
    v_exp_f32 v142, v142
    v_exp_f32 v143, v143
    v_cvt_pk_bf16_f32 v50, v132, v133
    v_cvt_pk_bf16_f32 v51, v134, v135
    v_cvt_pk_bf16_f32 v52, v136, v137
    v_cvt_pk_bf16_f32 v53, v138, v139
    v_cvt_pk_bf16_f32 v54, v140, v141
    v_cvt_pk_bf16_f32 v55, v142, v143
    s_waitcnt lgkmcnt(1)
    v_mfma_f32_32x32x16_bf16 v[128:143], v[24:27], v[8:11], 0
    v_exp_f32 v144, v144
    v_exp_f32 v145, v145
    v_exp_f32 v146, v146
    s_waitcnt lgkmcnt(0)
    v_mfma_f32_32x32x16_bf16 v[128:143], v[28:31], v[12:15], v[128:143]
    ds_read_b128 v[44:47], v1 offset:23552
    v_exp_f32 v147, v147
    v_exp_f32 v148, v148
    v_cvt_pk_bf16_f32 v56, v144, v145
    v_mfma_f32_32x32x16_bf16 v[160:175], v[32:35], v[48:51], v[160:175]
    ds_read_b128 v[40:43], v1 offset:22528
    v_exp_f32 v149, v149
    v_exp_f32 v150, v150
    v_cvt_pk_bf16_f32 v57, v146, v147
    v_mfma_f32_32x32x16_bf16 v[160:175], v[36:39], v[52:55], v[160:175]
    v_exp_f32 v151, v151
    v_exp_f32 v152, v152
    v_exp_f32 v153, v153
    v_exp_f32 v154, v154
    v_exp_f32 v155, v155
    v_exp_f32 v156, v156
    v_exp_f32 v157, v157
    v_exp_f32 v158, v158
    v_exp_f32 v159, v159
    v_cvt_pk_bf16_f32 v58, v148, v149
    v_cvt_pk_bf16_f32 v59, v150, v151
    v_cvt_pk_bf16_f32 v60, v152, v153
    v_cvt_pk_bf16_f32 v61, v154, v155
    v_cvt_pk_bf16_f32 v62, v156, v157
    v_cvt_pk_bf16_f32 v63, v158, v159
    v_mfma_f32_32x32x16_bf16 v[144:159], v[24:27], v[16:19], 0
    v_exp_f32 v128, v128
    v_exp_f32 v129, v129
    v_exp_f32 v130, v130
    v_mfma_f32_32x32x16_bf16 v[144:159], v[28:31], v[20:23], v[144:159]
    ds_read_b128 v[24:27], v1 offset:32768
    v_exp_f32 v131, v131
    v_exp_f32 v132, v132
    v_cvt_pk_bf16_f32 v48, v128, v129
    v_mfma_f32_32x32x16_bf16 v[176:191], v[32:35], v[56:59], v[176:191]
    ds_read_b128 v[28:31], v1 offset:33792
    v_exp_f32 v133, v133
    v_exp_f32 v134, v134
    v_cvt_pk_bf16_f32 v49, v130, v131
    v_mfma_f32_32x32x16_bf16 v[176:191], v[36:39], v[60:63], v[176:191]
    v_exp_f32 v135, v135
    v_exp_f32 v136, v136
    v_exp_f32 v137, v137
    v_exp_f32 v138, v138
    v_exp_f32 v139, v139
    v_exp_f32 v140, v140
    v_exp_f32 v141, v141
    v_exp_f32 v142, v142
    v_exp_f32 v143, v143
    v_cvt_pk_bf16_f32 v50, v132, v133
    v_cvt_pk_bf16_f32 v51, v134, v135
    v_cvt_pk_bf16_f32 v52, v136, v137
    v_cvt_pk_bf16_f32 v53, v138, v139
    v_cvt_pk_bf16_f32 v54, v140, v141
    v_cvt_pk_bf16_f32 v55, v142, v143
    s_waitcnt lgkmcnt(1)
    v_mfma_f32_32x32x16_bf16 v[128:143], v[24:27], v[8:11], 0
    v_exp_f32 v144, v144
    v_exp_f32 v145, v145
    v_exp_f32 v146, v146
    s_waitcnt lgkmcnt(0)
    v_mfma_f32_32x32x16_bf16 v[128:143], v[28:31], v[12:15], v[128:143]
    ds_read_b128 v[36:39], v1 offset:35840
    v_exp_f32 v147, v147
    v_exp_f32 v148, v148
    v_cvt_pk_bf16_f32 v56, v144, v145
    v_mfma_f32_32x32x16_bf16 v[160:175], v[40:43], v[48:51], v[160:175]
    ds_read_b128 v[32:35], v1 offset:34816
    v_exp_f32 v149, v149
    v_exp_f32 v150, v150
    v_cvt_pk_bf16_f32 v57, v146, v147
    v_mfma_f32_32x32x16_bf16 v[160:175], v[44:47], v[52:55], v[160:175]
    v_exp_f32 v151, v151
    v_exp_f32 v152, v152
    v_exp_f32 v153, v153
    v_exp_f32 v154, v154
    v_exp_f32 v155, v155
    v_exp_f32 v156, v156
    v_exp_f32 v157, v157
    v_exp_f32 v158, v158
    v_exp_f32 v159, v159
    v_cvt_pk_bf16_f32 v58, v148, v149
    v_cvt_pk_bf16_f32 v59, v150, v151
    v_cvt_pk_bf16_f32 v60, v152, v153
    v_cvt_pk_bf16_f32 v61, v154, v155
    v_cvt_pk_bf16_f32 v62, v156, v157
    v_cvt_pk_bf16_f32 v63, v158, v159
    s_waitcnt vmcnt(0)
    s_barrier
    v_mfma_f32_32x32x16_bf16 v[144:159], v[24:27], v[16:19], 0
    v_exp_f32 v128, v128
    v_exp_f32 v129, v129
    v_exp_f32 v130, v130
    v_mfma_f32_32x32x16_bf16 v[144:159], v[28:31], v[20:23], v[144:159]
    ds_read_b128 v[24:27], v1 offset:36864
    v_exp_f32 v131, v131
    v_exp_f32 v132, v132
    v_cvt_pk_bf16_f32 v48, v128, v129
    v_mfma_f32_32x32x16_bf16 v[176:191], v[40:43], v[56:59], v[176:191]
    ds_read_b128 v[28:31], v1 offset:37888
    v_exp_f32 v133, v133
    v_exp_f32 v134, v134
    v_cvt_pk_bf16_f32 v49, v130, v131
    v_mfma_f32_32x32x16_bf16 v[176:191], v[44:47], v[60:63], v[176:191]
    v_exp_f32 v135, v135
    v_exp_f32 v136, v136
    v_exp_f32 v137, v137
    v_exp_f32 v138, v138
    v_exp_f32 v139, v139
    v_exp_f32 v140, v140
    v_exp_f32 v141, v141
    v_exp_f32 v142, v142
    v_exp_f32 v143, v143
    v_cvt_pk_bf16_f32 v50, v132, v133
    v_cvt_pk_bf16_f32 v51, v134, v135
    v_cvt_pk_bf16_f32 v52, v136, v137
    v_cvt_pk_bf16_f32 v53, v138, v139
    v_cvt_pk_bf16_f32 v54, v140, v141
    v_cvt_pk_bf16_f32 v55, v142, v143
    s_waitcnt lgkmcnt(1)
    v_mfma_f32_32x32x16_bf16 v[128:143], v[24:27], v[8:11], 0
    v_exp_f32 v144, v144
    v_exp_f32 v145, v145
    v_exp_f32 v146, v146
    s_waitcnt lgkmcnt(0)
    v_mfma_f32_32x32x16_bf16 v[128:143], v[28:31], v[12:15], v[128:143]
    ds_read_b128 v[44:47], v1 offset:39936
    v_exp_f32 v147, v147
    v_exp_f32 v148, v148
    v_cvt_pk_bf16_f32 v56, v144, v145
    v_mfma_f32_32x32x16_bf16 v[160:175], v[32:35], v[48:51], v[160:175]
    ds_read_b128 v[40:43], v1 offset:38912
    v_exp_f32 v149, v149
    v_exp_f32 v150, v150
    v_cvt_pk_bf16_f32 v57, v146, v147
    v_mfma_f32_32x32x16_bf16 v[160:175], v[36:39], v[52:55], v[160:175]
    v_exp_f32 v151, v151
    v_exp_f32 v152, v152
    v_exp_f32 v153, v153
    v_exp_f32 v154, v154
    v_exp_f32 v155, v155
    v_exp_f32 v156, v156
    v_exp_f32 v157, v157
    v_exp_f32 v158, v158
    v_exp_f32 v159, v159
    v_cvt_pk_bf16_f32 v58, v148, v149
    v_cvt_pk_bf16_f32 v59, v150, v151
    v_cvt_pk_bf16_f32 v60, v152, v153
    v_cvt_pk_bf16_f32 v61, v154, v155
    v_cvt_pk_bf16_f32 v62, v156, v157
    v_cvt_pk_bf16_f32 v63, v158, v159
    v_mfma_f32_32x32x16_bf16 v[144:159], v[24:27], v[16:19], 0
    v_exp_f32 v128, v128
    v_exp_f32 v129, v129
    v_exp_f32 v130, v130
    v_mfma_f32_32x32x16_bf16 v[144:159], v[28:31], v[20:23], v[144:159]
    ds_read_b128 v[24:27], v1 offset:49152
    v_exp_f32 v131, v131
    v_exp_f32 v132, v132
    v_cvt_pk_bf16_f32 v48, v128, v129
    v_mfma_f32_32x32x16_bf16 v[176:191], v[32:35], v[56:59], v[176:191]
    ds_read_b128 v[28:31], v1 offset:50176
    v_exp_f32 v133, v133
    v_exp_f32 v134, v134
    v_cvt_pk_bf16_f32 v49, v130, v131
    v_mfma_f32_32x32x16_bf16 v[176:191], v[36:39], v[60:63], v[176:191]
    v_exp_f32 v135, v135
    v_exp_f32 v136, v136
    v_exp_f32 v137, v137
    v_exp_f32 v138, v138
    v_exp_f32 v139, v139
    v_exp_f32 v140, v140
    v_exp_f32 v141, v141
    v_exp_f32 v142, v142
    v_exp_f32 v143, v143
    v_cvt_pk_bf16_f32 v50, v132, v133
    v_cvt_pk_bf16_f32 v51, v134, v135
    v_cvt_pk_bf16_f32 v52, v136, v137
    v_cvt_pk_bf16_f32 v53, v138, v139
    v_cvt_pk_bf16_f32 v54, v140, v141
    v_cvt_pk_bf16_f32 v55, v142, v143
    s_waitcnt lgkmcnt(1)
    v_mfma_f32_32x32x16_bf16 v[128:143], v[24:27], v[8:11], 0
    v_exp_f32 v144, v144
    v_exp_f32 v145, v145
    v_exp_f32 v146, v146
    s_waitcnt lgkmcnt(0)
    v_mfma_f32_32x32x16_bf16 v[128:143], v[28:31], v[12:15], v[128:143]
    ds_read_b128 v[36:39], v1 offset:52224
    v_exp_f32 v147, v147
    v_exp_f32 v148, v148
    v_cvt_pk_bf16_f32 v56, v144, v145
    v_mfma_f32_32x32x16_bf16 v[160:175], v[40:43], v[48:51], v[160:175]
    ds_read_b128 v[32:35], v1 offset:51200
    v_exp_f32 v149, v149
    v_exp_f32 v150, v150
    v_cvt_pk_bf16_f32 v57, v146, v147
    v_mfma_f32_32x32x16_bf16 v[160:175], v[44:47], v[52:55], v[160:175]
    v_exp_f32 v151, v151
    v_exp_f32 v152, v152
    v_exp_f32 v153, v153
    v_exp_f32 v154, v154
    v_exp_f32 v155, v155
    v_exp_f32 v156, v156
    v_exp_f32 v157, v157
    v_exp_f32 v158, v158
    v_exp_f32 v159, v159
    v_cvt_pk_bf16_f32 v58, v148, v149
    v_cvt_pk_bf16_f32 v59, v150, v151
    v_cvt_pk_bf16_f32 v60, v152, v153
    v_cvt_pk_bf16_f32 v61, v154, v155
    v_cvt_pk_bf16_f32 v62, v156, v157
    v_cvt_pk_bf16_f32 v63, v158, v159
    s_barrier
    v_mfma_f32_32x32x16_bf16 v[144:159], v[24:27], v[16:19], 0
    v_exp_f32 v128, v128
    v_exp_f32 v129, v129
    v_exp_f32 v130, v130
    v_mfma_f32_32x32x16_bf16 v[144:159], v[28:31], v[20:23], v[144:159]
    ds_read_b128 v[24:27], v1 offset:53248
    v_exp_f32 v131, v131
    v_exp_f32 v132, v132
    v_cvt_pk_bf16_f32 v48, v128, v129
    v_mfma_f32_32x32x16_bf16 v[176:191], v[40:43], v[56:59], v[176:191]
    ds_read_b128 v[28:31], v1 offset:54272
    v_exp_f32 v133, v133
    v_exp_f32 v134, v134
    v_cvt_pk_bf16_f32 v49, v130, v131
    v_mfma_f32_32x32x16_bf16 v[176:191], v[44:47], v[60:63], v[176:191]
    v_exp_f32 v135, v135
    v_exp_f32 v136, v136
    v_exp_f32 v137, v137
    v_exp_f32 v138, v138
    v_exp_f32 v139, v139
    v_exp_f32 v140, v140
    v_exp_f32 v141, v141
    v_exp_f32 v142, v142
    v_exp_f32 v143, v143
    v_cvt_pk_bf16_f32 v50, v132, v133
    v_cvt_pk_bf16_f32 v51, v134, v135
    v_cvt_pk_bf16_f32 v52, v136, v137
    v_cvt_pk_bf16_f32 v53, v138, v139
    v_cvt_pk_bf16_f32 v54, v140, v141
    v_cvt_pk_bf16_f32 v55, v142, v143
    s_waitcnt lgkmcnt(1)
    v_mfma_f32_32x32x16_bf16 v[128:143], v[24:27], v[8:11], 0
    v_exp_f32 v144, v144
    v_exp_f32 v145, v145
    v_exp_f32 v146, v146
    s_waitcnt lgkmcnt(0)
    v_mfma_f32_32x32x16_bf16 v[128:143], v[28:31], v[12:15], v[128:143]
    ds_read_b128 v[44:47], v1 offset:56320
    v_exp_f32 v147, v147
    v_exp_f32 v148, v148
    v_cvt_pk_bf16_f32 v56, v144, v145
    v_mfma_f32_32x32x16_bf16 v[160:175], v[32:35], v[48:51], v[160:175]
    ds_read_b128 v[40:43], v1 offset:55296
    v_exp_f32 v149, v149
    v_exp_f32 v150, v150
    v_cvt_pk_bf16_f32 v57, v146, v147
    v_mfma_f32_32x32x16_bf16 v[160:175], v[36:39], v[52:55], v[160:175]
    v_exp_f32 v151, v151
    v_exp_f32 v152, v152
    v_exp_f32 v153, v153
    v_exp_f32 v154, v154
    v_exp_f32 v155, v155
    v_exp_f32 v156, v156
    v_exp_f32 v157, v157
    v_exp_f32 v158, v158
    v_exp_f32 v159, v159
    v_cvt_pk_bf16_f32 v58, v148, v149
    v_cvt_pk_bf16_f32 v59, v150, v151
    v_cvt_pk_bf16_f32 v60, v152, v153
    v_cvt_pk_bf16_f32 v61, v154, v155
    v_cvt_pk_bf16_f32 v62, v156, v157
    v_cvt_pk_bf16_f32 v63, v158, v159
    v_mfma_f32_32x32x16_bf16 v[144:159], v[24:27], v[16:19], 0
    v_exp_f32 v128, v128
    v_exp_f32 v129, v129
    v_exp_f32 v130, v130
    v_mfma_f32_32x32x16_bf16 v[144:159], v[28:31], v[20:23], v[144:159]
    ds_read_b128 v[24:27], v1 offset:0
    v_exp_f32 v131, v131
    v_exp_f32 v132, v132
    v_cvt_pk_bf16_f32 v48, v128, v129
    v_mfma_f32_32x32x16_bf16 v[176:191], v[32:35], v[56:59], v[176:191]
    ds_read_b128 v[28:31], v1 offset:1024
    v_exp_f32 v133, v133
    v_exp_f32 v134, v134
    v_cvt_pk_bf16_f32 v49, v130, v131
    v_mfma_f32_32x32x16_bf16 v[176:191], v[36:39], v[60:63], v[176:191]
    v_exp_f32 v135, v135
    v_exp_f32 v136, v136
    v_exp_f32 v137, v137
    v_exp_f32 v138, v138
    v_exp_f32 v139, v139
    v_exp_f32 v140, v140
    v_exp_f32 v141, v141
    v_exp_f32 v142, v142
    v_exp_f32 v143, v143
    v_cvt_pk_bf16_f32 v50, v132, v133
    v_cvt_pk_bf16_f32 v51, v134, v135
    v_cvt_pk_bf16_f32 v52, v136, v137
    v_cvt_pk_bf16_f32 v53, v138, v139
    v_cvt_pk_bf16_f32 v54, v140, v141
    v_cvt_pk_bf16_f32 v55, v142, v143
    s_waitcnt lgkmcnt(1)
    v_mfma_f32_32x32x16_bf16 v[128:143], v[24:27], v[8:11], 0
    v_exp_f32 v144, v144
    v_exp_f32 v145, v145
    v_exp_f32 v146, v146
    s_waitcnt lgkmcnt(0)
    v_mfma_f32_32x32x16_bf16 v[128:143], v[28:31], v[12:15], v[128:143]
    ds_read_b128 v[36:39], v1 offset:3072
    v_exp_f32 v147, v147
    v_exp_f32 v148, v148
    v_cvt_pk_bf16_f32 v56, v144, v145
    v_mfma_f32_32x32x16_bf16 v[160:175], v[40:43], v[48:51], v[160:175]
    ds_read_b128 v[32:35], v1 offset:2048
    v_exp_f32 v149, v149
    v_exp_f32 v150, v150
    v_cvt_pk_bf16_f32 v57, v146, v147
    v_mfma_f32_32x32x16_bf16 v[160:175], v[44:47], v[52:55], v[160:175]
    v_exp_f32 v151, v151
    v_exp_f32 v152, v152
    v_exp_f32 v153, v153
    v_exp_f32 v154, v154
    v_exp_f32 v155, v155
    v_exp_f32 v156, v156
    v_exp_f32 v157, v157
    v_exp_f32 v158, v158
    v_exp_f32 v159, v159
    v_cvt_pk_bf16_f32 v58, v148, v149
    v_cvt_pk_bf16_f32 v59, v150, v151
    v_cvt_pk_bf16_f32 v60, v152, v153
    v_cvt_pk_bf16_f32 v61, v154, v155
    v_cvt_pk_bf16_f32 v62, v156, v157
    v_cvt_pk_bf16_f32 v63, v158, v159
    s_add_u32 s38, s38, 1
    s_cmp_lt_u32 s38, 4
    s_barrier
    s_cbranch_scc1 L_k12_aloop
    v_mfma_f32_32x32x16_bf16 v[176:191], v[40:43], v[56:59], v[176:191]
    v_mfma_f32_32x32x16_bf16 v[176:191], v[44:47], v[60:63], v[176:191]
    s_waitcnt lgkmcnt(0)
    s_cmp_eq_u32 s30, 0
    s_cbranch_scc1 L_k12_kg0
    ds_write_b128 v2, v[160:163] offset:0
    ds_write_b128 v2, v[164:167] offset:1024
    ds_write_b128 v2, v[168:171] offset:2048
    ds_write_b128 v2, v[172:175] offset:3072
    s_nop 4
    v_mov_b32 v160, v176
    v_mov_b32 v161, v177
    v_mov_b32 v162, v178
    v_mov_b32 v163, v179
    v_mov_b32 v164, v180
    v_mov_b32 v165, v181
    v_mov_b32 v166, v182
    v_mov_b32 v167, v183
    v_mov_b32 v168, v184
    v_mov_b32 v169, v185
    v_mov_b32 v170, v186
    v_mov_b32 v171, v187
    v_mov_b32 v172, v188
    v_mov_b32 v173, v189
    v_mov_b32 v174, v190
    v_mov_b32 v175, v191
    v_mov_b32 v8, v16
    v_mov_b32 v9, v17
    v_mov_b32 v10, v18
    v_mov_b32 v11, v19
    v_mov_b32 v12, v20
    v_mov_b32 v13, v21
    v_mov_b32 v14, v22
    v_mov_b32 v15, v23
    v_add_u32 v2, 4096, v2
    s_branch L_k12_kgj
L_k12_kg0:
    s_nop 9
    ds_write_b128 v2, v[176:179] offset:4096
    ds_write_b128 v2, v[180:183] offset:5120
    ds_write_b128 v2, v[184:187] offset:6144
    ds_write_b128 v2, v[188:191] offset:7168
L_k12_kgj:
    s_waitcnt lgkmcnt(0)
    s_barrier
    ds_read_b128 v[192:195], v2 offset:0
    ds_read_b128 v[196:199], v2 offset:1024
    ds_read_b128 v[200:203], v2 offset:2048
    ds_read_b128 v[204:207], v2 offset:3072
    v_mov_b32 v208, 0
    v_mov_b32 v209, 0
    v_mov_b32 v210, 0
    v_mov_b32 v211, 0
    s_waitcnt lgkmcnt(3)
    v_pk_add_f32 v[160:161], v[160:161], v[192:193]
    v_pk_add_f32 v[162:163], v[162:163], v[194:195]
    s_waitcnt lgkmcnt(2)
    v_pk_add_f32 v[164:165], v[164:165], v[196:197]
    v_pk_add_f32 v[166:167], v[166:167], v[198:199]
    s_waitcnt lgkmcnt(1)
    v_pk_add_f32 v[168:169], v[168:169], v[200:201]
    v_pk_add_f32 v[170:171], v[170:171], v[202:203]
    s_waitcnt lgkmcnt(0)
    v_pk_add_f32 v[172:173], v[172:173], v[204:205]
    v_pk_add_f32 v[174:175], v[174:175], v[206:207]
    v_mov_b32 v4, v172
    v_mov_b32 v5, v172
    v_pk_fma_f32 v[208:209], v[160:161], v[210:211], v[208:209]
    v_pk_fma_f32 v[208:209], v[162:163], v[210:211], v[208:209]
    v_permlane32_swap_b32 v4, v5
    v_pk_fma_f32 v[208:209], v[164:165], v[210:211], v[208:209]
    v_pk_fma_f32 v[208:209], v[166:167], v[210:211], v[208:209]
    v_pk_fma_f32 v[208:209], v[168:169], v[210:211], v[208:209]
    v_pk_fma_f32 v[208:209], v[170:171], v[210:211], v[208:209]
    v_pk_fma_f32 v[208:209], v[172:173], v[210:211], v[208:209]
    v_pk_fma_f32 v[208:209], v[174:175], v[210:211], v[208:209]
    v_add_f32 v6, v208, v209
    s_mov_b32 s32, 0x26800000
    s_mov_b32 s33, 0x5d800000
    v_add_f32 v6, v6, v5
    v_cmp_le_f32 vcc, s32, v6
    v_cmp_ge_f32 s[40:41], s33, v6
    s_nop 0
    s_and_b64 vcc, vcc, s[40:41]
    s_cmp_eq_u64 vcc, -1
    s_cbranch_scc0 L_k12_slow
L_k12_store:
    s_nop 1
    v_rcp_f32 v4, v5
    v_cmp_gt_u32 vcc, 32, v253
    v_mov_b32 v6, 0
    v_mov_b32 v5, v4
    v_cndmask_b32 v6, v6, v4, vcc
    v_mov_b32 v7, v6
    v_pk_mul_f32 v[160:161], v[160:161], v[4:5]
    v_pk_mul_f32 v[162:163], v[162:163], v[4:5]
    v_pk_mul_f32 v[164:165], v[164:165], v[4:5]
    v_pk_mul_f32 v[166:167], v[166:167], v[4:5]
    v_pk_mul_f32 v[168:169], v[168:169], v[4:5]
    v_pk_mul_f32 v[170:171], v[170:171], v[4:5]
    v_pk_mul_f32 v[172:173], v[172:173], v[6:7]
    v_pk_mul_f32 v[174:175], v[174:175], v[6:7]
    v_cvt_pk_bf16_f32 v48, v160, v161
    v_cvt_pk_bf16_f32 v49, v162, v163
    v_cvt_pk_bf16_f32 v50, v164, v165
    v_cvt_pk_bf16_f32 v51, v166, v167
    v_cvt_pk_bf16_f32 v52, v168, v169
    v_cvt_pk_bf16_f32 v53, v170, v171
    v_cvt_pk_bf16_f32 v54, v172, v173
    v_cvt_pk_bf16_f32 v55, v174, v175
    buffer_store_dwordx4 v[48:51], v254, s[20:23], s36 offen offset:0 sc1
    buffer_store_dwordx4 v[52:55], v254, s[20:23], s36 offen offset:1024 sc1
    s_cmp_ge_u32 s69, 28
    s_cbranch_scc0 L_k12_h3
    s_waitcnt vmcnt(0)
    s_barrier
    s_branch L_k12_h3end
L_k12_h3:
    s_lshl_b32 s32, s28, 12
    s_add_u32 s32, s32, 65536
    v_add_u32 v1, s32, v254
    s_mul_i32 s32, s69, 37
    s_lshr_b32 s32, s32, 8
    s_mul_i32 s33, s32, 7
    s_sub_u32 s35, s69, s33
    s_lshl_b32 s34, s68, 2
    s_add_u32 s34, s34, s32
    s_and_b32 s29, s28, 1
    s_lshr_b32 s30, s28, 1
    s_mov_b32 s12, s92
    s_mov_b32 s13, s93
    s_mov_b32 s14, 1835008
    s_mov_b32 s15, 0x20000
    s_lshl_b32 s32, s34, 1
    s_add_u32 s32, s32, s30
    s_mul_i32 s36, s32, 28672
    s_lshl_b32 s31, s35, 1
    s_add_u32 s31, s31, s29
    s_lshl_b32 s31, s31, 6
    s_add_u32 s36, s36, s31
    s_lshl_b32 s37, s32, 8
    s_add_u32 s37, s37, 18874368
    v_and_b32 v250, 31, v253
    v_lshlrev_b32 v5, 3, v250
    v_mul_u32_u24 v4, 896, v250
    v_lshrrev_b32 v251, 5, v253
    v_lshl_add_u32 v4, v251, 4, v4
    v_bfe_u32 v250, v253, 2, 2
    v_lshl_add_u32 v250, v251, 2, v250
    v_bfe_u32 v252, v253, 4, 1
    v_lshlrev_b32 v252, 5, v252
    v_and_b32 v251, 3, v253
    v_lshl_add_u32 v252, v251, 3, v252
    v_lshl_add_u32 v252, v250, 7, v252
    v_bfe_u32 v251, v253, 3, 1
    v_xor_b32 v251, s29, v251
    v_lshl_add_u32 v2, v251, 6, v252
    s_lshl_b32 s32, s30, 15
    s_add_u32 s32, s32, 0
    v_add_u32 v3, s32, v254
    s_waitcnt vmcnt(0)
    s_barrier
    buffer_load_dwordx2 v[6:7], v5, s[20:23], s37 offen offset:0 sc1
    ds_read_b64_tr_b16 v[144:145], v2 offset:0
    ds_read_b64_tr_b16 v[146:147], v2 offset:1024
    ds_read_b64_tr_b16 v[148:149], v2 offset:2048
    ds_read_b64_tr_b16 v[150:151], v2 offset:3072
    ds_read_b64_tr_b16 v[152:153], v2 offset:3584
    ds_read_b64_tr_b16 v[154:155], v2 offset:4608
    ds_read_b64_tr_b16 v[156:157], v2 offset:5632
    ds_read_b64_tr_b16 v[158:159], v2 offset:6656
    ds_read_b64_tr_b16 v[160:161], v2 offset:7168
    ds_read_b64_tr_b16 v[162:163], v2 offset:8192
    ds_read_b64_tr_b16 v[164:165], v2 offset:9216
    ds_read_b64_tr_b16 v[166:167], v2 offset:10240
    ds_read_b64_tr_b16 v[168:169], v2 offset:10752
    ds_read_b64_tr_b16 v[170:171], v2 offset:11776
    ds_read_b64_tr_b16 v[172:173], v2 offset:12800
    ds_read_b64_tr_b16 v[174:175], v2 offset:13824
    ds_read_b64_tr_b16 v[176:177], v2 offset:14336
    ds_read_b64_tr_b16 v[178:179], v2 offset:15360
    ds_read_b64_tr_b16 v[180:181], v2 offset:16384
    ds_read_b64_tr_b16 v[182:183], v2 offset:17408
    ds_read_b64_tr_b16 v[184:185], v2 offset:17920
    ds_read_b64_tr_b16 v[186:187], v2 offset:18944
    ds_read_b64_tr_b16 v[188:189], v2 offset:19968
    ds_read_b64_tr_b16 v[190:191], v2 offset:20992
    ds_read_b64_tr_b16 v[192:193], v2 offset:21504
    ds_read_b64_tr_b16 v[194:195], v2 offset:22528
    ds_read_b64_tr_b16 v[196:197], v2 offset:23552
    ds_read_b64_tr_b16 v[198:199], v2 offset:24576
    ds_read_b64_tr_b16 v[200:201], v2 offset:25088
    ds_read_b64_tr_b16 v[202:203], v2 offset:26112
    ds_read_b64_tr_b16 v[204:205], v2 offset:27136
    ds_read_b64_tr_b16 v[206:207], v2 offset:28160
    ds_read_b64_tr_b16 v[208:209], v2 offset:28672
    ds_read_b64_tr_b16 v[210:211], v2 offset:29696
    ds_read_b64_tr_b16 v[212:213], v2 offset:30720
    ds_read_b64_tr_b16 v[214:215], v2 offset:31744
    ds_read_b64_tr_b16 v[216:217], v2 offset:32256
    ds_read_b64_tr_b16 v[218:219], v2 offset:33280
    ds_read_b64_tr_b16 v[220:221], v2 offset:34304
    ds_read_b64_tr_b16 v[222:223], v2 offset:35328
    ds_read_b64_tr_b16 v[224:225], v2 offset:35840
    ds_read_b64_tr_b16 v[226:227], v2 offset:36864
    ds_read_b64_tr_b16 v[228:229], v2 offset:37888
    ds_read_b64_tr_b16 v[230:231], v2 offset:38912
    ds_read_b64_tr_b16 v[232:233], v2 offset:39424
    ds_read_b64_tr_b16 v[234:235], v2 offset:40448
    ds_read_b64_tr_b16 v[236:237], v2 offset:41472
    ds_read_b64_tr_b16 v[238:239], v2 offset:42496
    ds_read_b64_tr_b16 v[240:241], v2 offset:43008
    ds_read_b64_tr_b16 v[242:243], v2 offset:44032
    ds_read_b64_tr_b16 v[244:245], v2 offset:45056
    ds_read_b64_tr_b16 v[246:247], v2 offset:46080
    ds_read_b64_tr_b16 v[40:41], v2 offset:46592
    ds_read_b64_tr_b16 v[42:43], v2 offset:47616
    ds_read_b64_tr_b16 v[44:45], v2 offset:48640
    ds_read_b64_tr_b16 v[46:47], v2 offset:49664
    ds_read_b64_tr_b16 v[48:49], v2 offset:50176
    ds_read_b64_tr_b16 v[50:51], v2 offset:51200
    ds_read_b64_tr_b16 v[52:53], v2 offset:52224
    ds_read_b64_tr_b16 v[54:55], v2 offset:53248
    ds_read_b64_tr_b16 v[56:57], v2 offset:53760
    ds_read_b64_tr_b16 v[58:59], v2 offset:54784
    ds_read_b64_tr_b16 v[60:61], v2 offset:55808
    ds_read_b64_tr_b16 v[62:63], v2 offset:56832
    s_waitcnt lgkmcnt(0)
    s_barrier
    ds_read_b128 v[64:67], v1 offset:0
    ds_read_b128 v[68:71], v1 offset:1024
    ds_read_b128 v[72:75], v1 offset:2048
    ds_read_b128 v[76:79], v1 offset:3072
    ds_read_b128 v[80:83], v1 offset:16384
    ds_read_b128 v[84:87], v1 offset:17408
    ds_read_b128 v[88:91], v1 offset:18432
    ds_read_b128 v[92:95], v1 offset:19456
    ds_read_b128 v[96:99], v1 offset:32768
    ds_read_b128 v[100:103], v1 offset:33792
    ds_read_b128 v[104:107], v1 offset:34816
    ds_read_b128 v[108:111], v1 offset:35840
    ds_read_b128 v[112:115], v1 offset:49152
    ds_read_b128 v[116:119], v1 offset:50176
    ds_read_b128 v[120:123], v1 offset:51200
    ds_read_b128 v[124:127], v1 offset:52224
    s_waitcnt lgkmcnt(11)
    v_pk_add_f32 v[64:65], v[64:65], v[80:81]
    s_waitcnt lgkmcnt(3)
    v_pk_add_f32 v[96:97], v[96:97], v[112:113]
    v_pk_add_f32 v[66:67], v[66:67], v[82:83]
    v_pk_add_f32 v[98:99], v[98:99], v[114:115]
    v_pk_add_f32 v[68:69], v[68:69], v[84:85]
    s_waitcnt lgkmcnt(2)
    v_pk_add_f32 v[100:101], v[100:101], v[116:117]
    v_pk_add_f32 v[70:71], v[70:71], v[86:87]
    v_pk_add_f32 v[102:103], v[102:103], v[118:119]
    v_pk_add_f32 v[72:73], v[72:73], v[88:89]
    s_waitcnt lgkmcnt(1)
    v_pk_add_f32 v[104:105], v[104:105], v[120:121]
    v_pk_add_f32 v[74:75], v[74:75], v[90:91]
    v_pk_add_f32 v[106:107], v[106:107], v[122:123]
    v_pk_add_f32 v[76:77], v[76:77], v[92:93]
    s_waitcnt lgkmcnt(0)
    v_pk_add_f32 v[108:109], v[108:109], v[124:125]
    v_pk_add_f32 v[78:79], v[78:79], v[94:95]
    v_pk_add_f32 v[110:111], v[110:111], v[126:127]
    v_pk_add_f32 v[64:65], v[64:65], v[96:97]
    v_pk_add_f32 v[66:67], v[66:67], v[98:99]
    v_pk_add_f32 v[68:69], v[68:69], v[100:101]
    v_pk_add_f32 v[70:71], v[70:71], v[102:103]
    v_pk_add_f32 v[72:73], v[72:73], v[104:105]
    v_pk_add_f32 v[74:75], v[74:75], v[106:107]
    v_pk_add_f32 v[76:77], v[76:77], v[108:109]
    v_pk_add_f32 v[78:79], v[78:79], v[110:111]
    v_cvt_pk_bf16_f32 v80, v64, v65
    v_cvt_pk_bf16_f32 v81, v66, v67
    v_cvt_pk_bf16_f32 v82, v68, v69
    v_cvt_pk_bf16_f32 v83, v70, v71
    v_cvt_pk_bf16_f32 v84, v72, v73
    v_cvt_pk_bf16_f32 v85, v74, v75
    v_cvt_pk_bf16_f32 v86, v76, v77
    v_cvt_pk_bf16_f32 v87, v78, v79
    v_lshlrev_b32 v64, 16, v80
    v_and_b32 v65, 0xffff0000, v80
    v_lshlrev_b32 v66, 16, v81
    v_and_b32 v67, 0xffff0000, v81
    v_lshlrev_b32 v68, 16, v82
    v_and_b32 v69, 0xffff0000, v82
    v_lshlrev_b32 v70, 16, v83
    v_and_b32 v71, 0xffff0000, v83
    v_lshlrev_b32 v72, 16, v84
    v_and_b32 v73, 0xffff0000, v84
    v_lshlrev_b32 v74, 16, v85
    v_and_b32 v75, 0xffff0000, v85
    v_lshlrev_b32 v76, 16, v86
    v_and_b32 v77, 0xffff0000, v86
    v_lshlrev_b32 v78, 16, v87
    v_and_b32 v79, 0xffff0000, v87
    s_waitcnt vmcnt(0)
    v_mul_f32 v64, v64, v7
    v_mul_f32 v65, v65, v7
    v_mul_f32 v66, v66, v7
    v_mul_f32 v67, v67, v7
    v_mul_f32 v68, v68, v7
    v_mul_f32 v69, v69, v7
    v_mul_f32 v70, v70, v7
    v_mul_f32 v71, v71, v7
    v_mul_f32 v72, v72, v7
    v_mul_f32 v73, v73, v7
    v_mul_f32 v74, v74, v7
    v_mul_f32 v75, v75, v7
    v_mul_f32 v76, v76, v7
    v_mul_f32 v77, v77, v7
    v_mul_f32 v78, v78, v7
    v_mul_f32 v79, v79, v7
    s_barrier
    ds_read_b128 v[8:11], v3 offset:0
    ds_read_b128 v[12:15], v3 offset:1024
    ds_read_b128 v[16:19], v3 offset:2048
    ds_read_b128 v[20:23], v3 offset:3072
    ds_read_b128 v[24:27], v3 offset:4096
    ds_read_b128 v[28:31], v3 offset:5120
    ds_read_b128 v[32:35], v3 offset:6144
    ds_read_b128 v[36:39], v3 offset:7168
    s_waitcnt lgkmcnt(7)
    v_mfma_f32_32x32x16_bf16 v[128:143], v[144:147], v[8:11], 0
    s_waitcnt lgkmcnt(6)
    v_mfma_f32_32x32x16_bf16 v[128:143], v[148:151], v[12:15], v[128:143]
    s_waitcnt lgkmcnt(5)
    v_mfma_f32_32x32x16_bf16 v[128:143], v[152:155], v[16:19], v[128:143]
    s_waitcnt lgkmcnt(4)
    v_mfma_f32_32x32x16_bf16 v[128:143], v[156:159], v[20:23], v[128:143]
    s_waitcnt lgkmcnt(3)
    v_mfma_f32_32x32x16_bf16 v[128:143], v[160:163], v[24:27], v[128:143]
    s_waitcnt lgkmcnt(2)
    v_mfma_f32_32x32x16_bf16 v[128:143], v[164:167], v[28:31], v[128:143]
    s_waitcnt lgkmcnt(1)
    v_mfma_f32_32x32x16_bf16 v[128:143], v[168:171], v[32:35], v[128:143]
    s_waitcnt lgkmcnt(0)
    v_mfma_f32_32x32x16_bf16 v[128:143], v[172:175], v[36:39], v[128:143]
    s_barrier
    ds_read_b128 v[8:11], v3 offset:8192
    ds_read_b128 v[12:15], v3 offset:9216
    ds_read_b128 v[16:19], v3 offset:10240
    ds_read_b128 v[20:23], v3 offset:11264
    ds_read_b128 v[24:27], v3 offset:12288
    ds_read_b128 v[28:31], v3 offset:13312
    ds_read_b128 v[32:35], v3 offset:14336
    ds_read_b128 v[36:39], v3 offset:15360
    s_waitcnt lgkmcnt(7)
    v_mfma_f32_32x32x16_bf16 v[128:143], v[176:179], v[8:11], v[128:143]
    s_waitcnt lgkmcnt(6)
    v_mfma_f32_32x32x16_bf16 v[128:143], v[180:183], v[12:15], v[128:143]
    s_waitcnt lgkmcnt(5)
    v_mfma_f32_32x32x16_bf16 v[128:143], v[184:187], v[16:19], v[128:143]
    s_waitcnt lgkmcnt(4)
    v_mfma_f32_32x32x16_bf16 v[128:143], v[188:191], v[20:23], v[128:143]
    s_waitcnt lgkmcnt(3)
    v_mfma_f32_32x32x16_bf16 v[128:143], v[192:195], v[24:27], v[128:143]
    s_waitcnt lgkmcnt(2)
    v_mfma_f32_32x32x16_bf16 v[128:143], v[196:199], v[28:31], v[128:143]
    s_waitcnt lgkmcnt(1)
    v_mfma_f32_32x32x16_bf16 v[128:143], v[200:203], v[32:35], v[128:143]
    s_waitcnt lgkmcnt(0)
    v_mfma_f32_32x32x16_bf16 v[128:143], v[204:207], v[36:39], v[128:143]
    s_barrier
    ds_read_b128 v[8:11], v3 offset:16384
    ds_read_b128 v[12:15], v3 offset:17408
    ds_read_b128 v[16:19], v3 offset:18432
    ds_read_b128 v[20:23], v3 offset:19456
    ds_read_b128 v[24:27], v3 offset:20480
    ds_read_b128 v[28:31], v3 offset:21504
    ds_read_b128 v[32:35], v3 offset:22528
    ds_read_b128 v[36:39], v3 offset:23552
    s_waitcnt lgkmcnt(7)
    v_mfma_f32_32x32x16_bf16 v[128:143], v[208:211], v[8:11], v[128:143]
    s_waitcnt lgkmcnt(6)
    v_mfma_f32_32x32x16_bf16 v[128:143], v[212:215], v[12:15], v[128:143]
    s_waitcnt lgkmcnt(5)
    v_mfma_f32_32x32x16_bf16 v[128:143], v[216:219], v[16:19], v[128:143]
    s_waitcnt lgkmcnt(4)
    v_mfma_f32_32x32x16_bf16 v[128:143], v[220:223], v[20:23], v[128:143]
    s_waitcnt lgkmcnt(3)
    v_mfma_f32_32x32x16_bf16 v[128:143], v[224:227], v[24:27], v[128:143]
    s_waitcnt lgkmcnt(2)
    v_mfma_f32_32x32x16_bf16 v[128:143], v[228:231], v[28:31], v[128:143]
    s_waitcnt lgkmcnt(1)
    v_mfma_f32_32x32x16_bf16 v[128:143], v[232:235], v[32:35], v[128:143]
    s_waitcnt lgkmcnt(0)
    v_mfma_f32_32x32x16_bf16 v[128:143], v[236:239], v[36:39], v[128:143]
    s_barrier
    ds_read_b128 v[8:11], v3 offset:24576
    ds_read_b128 v[12:15], v3 offset:25600
    ds_read_b128 v[16:19], v3 offset:26624
    ds_read_b128 v[20:23], v3 offset:27648
    ds_read_b128 v[24:27], v3 offset:28672
    ds_read_b128 v[28:31], v3 offset:29696
    ds_read_b128 v[32:35], v3 offset:30720
    ds_read_b128 v[36:39], v3 offset:31744
    s_waitcnt lgkmcnt(7)
    v_mfma_f32_32x32x16_bf16 v[128:143], v[240:243], v[8:11], v[128:143]
    s_waitcnt lgkmcnt(6)
    v_mfma_f32_32x32x16_bf16 v[128:143], v[244:247], v[12:15], v[128:143]
    s_waitcnt lgkmcnt(5)
    v_mfma_f32_32x32x16_bf16 v[128:143], v[40:43], v[16:19], v[128:143]
    s_waitcnt lgkmcnt(4)
    v_mfma_f32_32x32x16_bf16 v[128:143], v[44:47], v[20:23], v[128:143]
    s_waitcnt lgkmcnt(3)
    v_mfma_f32_32x32x16_bf16 v[128:143], v[48:51], v[24:27], v[128:143]
    s_waitcnt lgkmcnt(2)
    v_mfma_f32_32x32x16_bf16 v[128:143], v[52:55], v[28:31], v[128:143]
    s_waitcnt lgkmcnt(1)
    v_mfma_f32_32x32x16_bf16 v[128:143], v[56:59], v[32:35], v[128:143]
    s_waitcnt lgkmcnt(0)
    v_mfma_f32_32x32x16_bf16 v[128:143], v[60:63], v[36:39], v[128:143]
    s_nop 11
    v_fmac_f32 v64, v128, v6
    v_fmac_f32 v65, v129, v6
    v_fmac_f32 v66, v130, v6
    v_fmac_f32 v67, v131, v6
    v_fmac_f32 v68, v132, v6
    v_fmac_f32 v69, v133, v6
    v_fmac_f32 v70, v134, v6
    v_fmac_f32 v71, v135, v6
    v_fmac_f32 v72, v136, v6
    v_fmac_f32 v73, v137, v6
    v_fmac_f32 v74, v138, v6
    v_fmac_f32 v75, v139, v6
    v_fmac_f32 v76, v140, v6
    v_fmac_f32 v77, v141, v6
    v_fmac_f32 v78, v142, v6
    v_fmac_f32 v79, v143, v6
    v_cvt_pk_bf16_f32 v112, v64, v65
    v_cvt_pk_bf16_f32 v113, v66, v67
    v_cvt_pk_bf16_f32 v114, v68, v69
    v_cvt_pk_bf16_f32 v115, v70, v71
    v_cvt_pk_bf16_f32 v116, v72, v73
    v_cvt_pk_bf16_f32 v117, v74, v75
    v_cvt_pk_bf16_f32 v118, v76, v77
    v_cvt_pk_bf16_f32 v119, v78, v79
    v_permlane32_swap_b32 v112, v114
    v_permlane32_swap_b32 v113, v115
    buffer_store_dwordx4 v[112:115], v4, s[12:15], s36 offen offset:0
    v_permlane32_swap_b32 v116, v118
    v_permlane32_swap_b32 v117, v119
    buffer_store_dwordx4 v[116:119], v4, s[12:15], s36 offen offset:32
L_k12_h3end:
    s_endpgm
L_k12_slow:
    v_mov_b32 v7, 0xff800000
    v_mov_b32 v160, 0
    v_mov_b32 v161, 0
    v_mov_b32 v162, 0
    v_mov_b32 v163, 0
    v_mov_b32 v164, 0
    v_mov_b32 v165, 0
    v_mov_b32 v166, 0
    v_mov_b32 v167, 0
    v_mov_b32 v168, 0
    v_mov_b32 v169, 0
    v_mov_b32 v170, 0
    v_mov_b32 v171, 0
    v_mov_b32 v172, 0
    v_mov_b32 v173, 0
    v_mov_b32 v174, 0
    v_mov_b32 v175, 0
    s_mov_b32 s38, 0
    s_mov_b32 s31, s37
L_k12_slow_loop:
    buffer_load_dwordx4 v[24:27], v254, s[20:23], s31 offen offset:0 sc1
    buffer_load_dwordx4 v[28:31], v254, s[20:23], s31 offen offset:1024 sc1
    buffer_load_dwordx4 v[32:35], v254, s[20:23], s31 offen offset:2048 sc1
    buffer_load_dwordx4 v[36:39], v254, s[20:23], s31 offen offset:3072 sc1
    s_waitcnt vmcnt(3)
    v_mfma_f32_32x32x16_bf16 v[128:143], v[24:27], v[8:11], 0
    s_waitcnt vmcnt(2)
    v_mfma_f32_32x32x16_bf16 v[128:143], v[28:31], v[12:15], v[128:143]
    s_nop 11
    v_max_f32 v4, v128, v129
    v_max3_f32 v4, v4, v130, v131
    v_max3_f32 v4, v4, v132, v133
    v_max3_f32 v4, v4, v134, v135
    v_max3_f32 v4, v4, v136, v137
    v_max3_f32 v4, v4, v138, v139
    v_max3_f32 v4, v4, v140, v141
    v_max3_f32 v4, v4, v142, v143
    v_mov_b32 v5, v4
    s_nop 1
    v_permlane32_swap_b32 v4, v5
    v_max3_f32 v4, v4, v5, v7
    v_sub_f32 v5, v7, v4
    v_exp_f32 v5, v5
    v_mov_b32 v7, v4
    v_sub_f32 v128, v128, v7
    v_sub_f32 v129, v129, v7
    v_sub_f32 v130, v130, v7
    v_sub_f32 v131, v131, v7
    v_sub_f32 v132, v132, v7
    v_sub_f32 v133, v133, v7
    v_sub_f32 v134, v134, v7
    v_sub_f32 v135, v135, v7
    v_sub_f32 v136, v136, v7
    v_sub_f32 v137, v137, v7
    v_sub_f32 v138, v138, v7
    v_sub_f32 v139, v139, v7
    v_sub_f32 v140, v140, v7
    v_sub_f32 v141, v141, v7
    v_sub_f32 v142, v142, v7
    v_sub_f32 v143, v143, v7
    v_exp_f32 v128, v128
    v_exp_f32 v129, v129
    v_exp_f32 v130, v130
    v_exp_f32 v131, v131
    v_exp_f32 v132, v132
    v_exp_f32 v133, v133
    v_exp_f32 v134, v134
    v_exp_f32 v135, v135
    v_exp_f32 v136, v136
    v_exp_f32 v137, v137
    v_exp_f32 v138, v138
    v_exp_f32 v139, v139
    v_exp_f32 v140, v140
    v_exp_f32 v141, v141
    v_exp_f32 v142, v142
    v_exp_f32 v143, v143
    v_mul_f32 v160, v160, v5
    v_mul_f32 v161, v161, v5
    v_mul_f32 v162, v162, v5
    v_mul_f32 v163, v163, v5
    v_mul_f32 v164, v164, v5
    v_mul_f32 v165, v165, v5
    v_mul_f32 v166, v166, v5
    v_mul_f32 v167, v167, v5
    v_mul_f32 v168, v168, v5
    v_mul_f32 v169, v169, v5
    v_mul_f32 v170, v170, v5
    v_mul_f32 v171, v171, v5
    v_mul_f32 v172, v172, v5
    v_mul_f32 v173, v173, v5
    v_mul_f32 v174, v174, v5
    v_mul_f32 v175, v175, v5
    v_cvt_pk_bf16_f32 v48, v128, v129
    v_cvt_pk_bf16_f32 v49, v130, v131
    v_cvt_pk_bf16_f32 v50, v132, v133
    v_cvt_pk_bf16_f32 v51, v134, v135
    v_cvt_pk_bf16_f32 v52, v136, v137
    v_cvt_pk_bf16_f32 v53, v138, v139
    v_cvt_pk_bf16_f32 v54, v140, v141
    v_cvt_pk_bf16_f32 v55, v142, v143
    s_waitcnt vmcnt(1)
    v_mfma_f32_32x32x16_bf16 v[160:175], v[32:35], v[48:51], v[160:175]
    s_waitcnt vmcnt(0)
    v_mfma_f32_32x32x16_bf16 v[160:175], v[36:39], v[52:55], v[160:175]
    s_add_u32 s31, s31, 4096
    s_add_u32 s38, s38, 1
    s_nop 9
    s_cmp_lt_u32 s38, 64
    s_cbranch_scc1 L_k12_slow_loop
    v_mov_b32 v4, v172
    v_mov_b32 v5, v172
    s_nop 1
    v_permlane32_swap_b32 v4, v5
    s_branch L_k12_store
L_k12_end:
    s_endpgm
L_code_end:
.section .rodata,"a"
.p2align 6
.amdhsa_kernel gated_mix__softmax_full_mha__swiglu_ffn__prompt_kernel
  .amdhsa_next_free_vgpr 256
  .amdhsa_next_free_sgpr 96
  .amdhsa_accum_offset 256
  .amdhsa_group_segment_fixed_size 0
  .amdhsa_kernarg_size 88
  .amdhsa_user_sgpr_count 2
  .amdhsa_user_sgpr_kernarg_segment_ptr 1
  .amdhsa_system_sgpr_workgroup_id_x 1
.end_amdhsa_kernel
```
